```python
import torch

def _softmax(x, axis=-1):
    return torch.softmax(x, dim=axis)
def _gelu(x):
    return torch.nn.functional.gelu(x, approximate="tanh")
def _silu(x):
    return torch.nn.functional.silu(x)
def _sigmoid(x):
    return torch.sigmoid(x)
def _layernorm(x, axis=-1, eps=1e-5):
    m = x.mean(dim=axis, keepdim=True)
    v = x.var(dim=axis, keepdim=True, unbiased=False)
    return (x - m) / torch.sqrt(v + eps)
def _scatter_add(tgt, idx, src, axis=0):
    return tgt.clone().index_add_(axis, idx, src)
def _segment_sum(src, seg, n):
    out = torch.zeros((n,) + src.shape[1:], dtype=src.dtype)
    return out.index_add_(0, seg, src)
def _pad(x, pw):
    flat = tuple(v for pair in reversed(pw) for v in pair)
    return torch.nn.functional.pad(x, flat)

kernel_name = 'parallel_sum__sliding_block__geglu_ffn__prompt'

def setup_inputs():

    _w = (lambda a: (lambda t: t.to(torch.bfloat16) if t.is_floating_point() else t)(torch.as_tensor(a)))
    def _A_setup():
        B, S, D = 1, 2048, 448
        return {
            "x": _w((lambda *s: torch.randn(*s, dtype=torch.bfloat16) * 0.05)(B, S, D)),
            "wqkv": _w((lambda *s: torch.randn(*s, dtype=torch.bfloat16) * 0.1)(D, 3 * D)),
            "wo": _w((lambda *s: torch.randn(*s, dtype=torch.bfloat16) * 0.05)(D, D)),
        }
    _A_in = _A_setup()

    def _B_setup():
        B, S, D, F = 1, 2048, 448, 1792
        return {
            "x": _w((lambda *s: torch.randn(*s, dtype=torch.bfloat16) * 0.05)(B, S, D)),
            "w_gate": _w((lambda *s: torch.randn(*s, dtype=torch.bfloat16) * 0.05)(D, F)),
            "w_up": _w((lambda *s: torch.randn(*s, dtype=torch.bfloat16) * 0.05)(D, F)),
            "w_down": _w((lambda *s: torch.randn(*s, dtype=torch.bfloat16) * 0.05)(F, D)),
        }
    _B_in = _B_setup()

    return {
        "A_x": _A_in["x"],
        "A_wqkv": _A_in["wqkv"],
        "A_wo": _A_in["wo"],
        "B_x": _B_in["x"],
        "B_w_gate": _B_in["w_gate"],
        "B_w_up": _B_in["w_up"],
        "B_w_down": _B_in["w_down"],
    }

def reference(A_x, A_wqkv, A_wo, B_x, B_w_gate, B_w_up, B_w_down):
    def _A_ref(x, wqkv, wo):
        B, S, D = x.shape
        H = 16; Dh = D // H; W = 256
        qkv = (lambda x, *d: x.permute(*d))((x @ wqkv).reshape(B, S, 3, H, Dh), 2, 0, 3, 1, 4)
        q, k, v = qkv[0], qkv[1], qkv[2]
        scores = torch.einsum("bhqd,bhkd->bhqk", q, k) * (Dh ** -0.5)
        idx = torch.arange(S)
        mask = (idx[:, None] - idx[None, :] >= 0) & (idx[:, None] - idx[None, :] < W)
        scores = torch.where(mask[None, None], scores, -1e9)
        p = _softmax(scores, axis=-1)
        o = torch.einsum("bhqk,bhkd->bhqd", p, v)
        return (lambda x, *d: x.permute(*d))(o, 0, 2, 1, 3).reshape(B, S, D) @ wo

    def _B_ref(x, w_gate, w_up, w_down):
        return (_gelu(x @ w_gate) * (x @ w_up)) @ w_down

    x = A_x
    xn = _layernorm(x, axis=-1)
    return x + _A_ref(xn, A_wqkv, A_wo) + _B_ref(xn, B_w_gate, B_w_up, B_w_down)
```

```asm
; @launch grid=(256,1,1) block=(512,1,1) lds=163840
.amdgcn_target "amdgcn-amd-amdhsa--gfx950"
.text
.globl parallel_sum__sliding_block__geglu_ffn__prompt_kernel
.p2align 8
.type parallel_sum__sliding_block__geglu_ffn__prompt_kernel,@function
parallel_sum__sliding_block__geglu_ffn__prompt_kernel:

    s_cmp_ge_u32 s2, 256
    s_cbranch_scc1 L_end
    s_load_dwordx16 s[16:31], s[0:1], 0
    s_load_dwordx4 s[32:35], s[0:1], 64
    s_memrealtime s[78:79]
    s_getpc_b64 s[96:97]
    s_and_b32 s74, s2, 0xf8
    v_add_lshl_u32 v26, v0, s74, 7
    v_min_u32 v26, 27000, v26
    v_cmp_gt_u32 vcc, 8, v0
    s_nop 0
    s_and_saveexec_b64 s[74:75], vcc
    s_nop 2
    s_cbranch_execz L_noct
    global_load_dword v247, v26, s[96:97]
L_noct:
    s_mov_b64 exec, -1
    v_and_b32 v1, 63, v0
    v_lshrrev_b32 v16, 6, v0
    s_nop 0
    v_readfirstlane_b32 s68, v16
    s_and_b32 s69, s2, 3
    s_bfe_u32 s76, s2, 0x20003
    s_lshl2_add_u32 s69, s69, s76
    s_bfe_u32 s70, s2, 0x10002
    s_lshr_b32 s75, s2, 5
    s_lshl3_add_u32 s70, s70, s75
    s_lshr_b32 s71, s68, 2
    s_and_b32 s72, s68, 3
    s_and_b32 s74, s70, 1
    s_and_b32 s75, s70, 2
    s_lshl2_add_u32 s74, s75, s74
    s_lshl_b32 s3, s68, 1
    s_xor_b32 s3, s3, s74
    v_lshrrev_b32 v16, 3, v1
    v_and_b32 v17, 7, v1
    v_mul_u32_u24 v44, 896, v16
    v_lshl_add_u32 v44, v17, 4, v44
    s_lshl4_add_u32 s74, s69, s3
    s_mul_i32 s80, s74, 7168
    s_xor_b32 s74, s74, 1
    s_mul_i32 s81, s74, 7168
    v_mov_b32 v250, 2147483392
    s_waitcnt lgkmcnt(0)
    s_mov_b32 s36, s16
    s_and_b32 s37, s17, 0xffff
    s_mov_b32 s38, 1835008
    s_mov_b32 s39, 0x00020000
    s_mov_b32 s40, s18
    s_and_b32 s41, s19, 0xffff
    s_mov_b32 s42, 1204224
    s_mov_b32 s43, 0x00020000
    s_cmp_ge_u32 s68, 4
    s_cbranch_scc1 L_x0skip0
    buffer_load_dwordx4 v[64:67], v44, s[36:39], s80 offen offset:0
    buffer_load_dwordx4 v[68:71], v44, s[36:39], s80 offen offset:128
    buffer_load_dwordx4 v[72:75], v44, s[36:39], s80 offen offset:256
    buffer_load_dwordx4 v[76:79], v44, s[36:39], s80 offen offset:384
    buffer_load_dwordx4 v[80:83], v44, s[36:39], s80 offen offset:512
    buffer_load_dwordx4 v[84:87], v44, s[36:39], s80 offen offset:640
    buffer_load_dwordx4 v[88:91], v44, s[36:39], s80 offen offset:768
    buffer_load_dwordx4 v[92:95], v44, s[36:39], s81 offen offset:0
    buffer_load_dwordx4 v[96:99], v44, s[36:39], s81 offen offset:128
L_x0skip0:
    s_cmp_lg_u32 s71, 0
    s_cbranch_scc1 L_x0skip
    s_lshl2_add_u32 s74, s2, s72
    s_mul_i32 s74, s74, 10
    v_min_u32 v26, 9, v1
    v_add_lshl_u32 v26, v26, s74, 7
    s_mov_b64 exec, 1023
    buffer_load_dword v247, v26, s[40:43], 0 offen
    s_mov_b64 exec, -1
L_x0skip:
    s_cmp_eq_u32 s71, 0
    s_cselect_b32 s44, s24, s26
    s_cselect_b32 s45, s25, s27
    s_and_b32 s45, s45, 0xffff
    s_mov_b32 s46, 1605632
    s_mov_b32 s47, 0x00020000
    s_mov_b32 s64, s32
    s_and_b32 s65, s33, 0xffff
    s_mov_b32 s66, 256
    s_mov_b32 s67, 0x00020000
    s_or_b32 s78, s78, 1
    v_mov_b32 v248, s78
    v_mov_b32 v249, s79
    v_cmp_eq_u32 s[96:97], 0, v0
    s_nop 1
    v_cndmask_b32 v252, v250, 0, s[96:97]
    s_cmp_eq_u32 s2, 0
    s_cselect_b64 s[96:97], s[96:97], 0
    v_cndmask_b32 v246, v250, 0, s[96:97]
    v_mov_b32 v251, 0
    v_bfe_u32 v18, v1, 4, 1
    v_lshlrev_b32 v19, 2, v18
    v_xor_b32 v19, v19, v17
    v_mul_u32_u24 v2, 2688, v16
    v_lshl_add_u32 v2, v19, 4, v2
    v_lshlrev_b32 v19, 1, v18
    v_xor_b32 v19, v19, v17
    s_lshl_b32 s75, s71, 2
    v_xor_b32 v19, s75, v19
    v_mul_u32_u24 v3, 3584, v16
    v_lshl_add_u32 v3, v19, 4, v3
    s_lshl_b32 s74, s3, 3
    v_add_u32 v18, s74, v16
    v_bfe_u32 v19, v18, 1, 3
    v_xor_b32 v19, v19, v17
    v_lshlrev_b32 v18, 7, v18
    v_lshl_add_u32 v18, v19, 4, v18
    v_add_u32 v40, 49152, v18
    v_add_u32 v42, 114688, v18
    v_add_u32 v18, s74, v16
    v_xor_b32 v18, 8, v18
    v_bfe_u32 v19, v18, 1, 3
    v_xor_b32 v19, v19, v17
    v_lshlrev_b32 v18, 7, v18
    v_lshl_add_u32 v18, v19, 4, v18
    v_add_u32 v41, 49152, v18
    v_add_u32 v43, 114688, v18
    s_mul_i32 s8, s72, 28672
    s_mul_i32 s9, s72, 14336
    s_add_u32 s9, s9, 344064
    s_mul_i32 s4, s68, 21504
    s_mul_i32 s6, s68, 10752
    s_add_u32 s5, s6, 344064
    s_lshr_b32 s74, s70, 2
    s_mul_i32 s75, s74, 224
    s_add_u32 s75, s75, 1792
    s_mul_i32 s7, s68, 5376
    s_add_u32 s6, s6, s75
    s_add_u32 s7, s7, s75
    s_add_u32 s7, s7, 258048
    s_mul_i32 s75, s70, 112
    s_add_u32 s4, s4, s75
    s_add_u32 s5, s5, s75
    s_mul_i32 s75, s74, 448
    s_and_b32 s74, s70, 3
    s_lshl_b32 s77, s74, 7
    s_add_u32 s75, s75, s77
    s_lshl1_add_u32 s8, s75, s8
    s_lshl1_add_u32 s9, s75, s9
    s_lshl_b32 s77, s75, 6
    s_mul_i32 s10, s71, 14336
    s_lshl_b32 s75, s72, 9
    s_add_u32 s11, s10, s75
    s_add_u32 s11, s11, 12288
    s_lshl1_add_u32 s10, s75, s10
    s_lshl_b32 s22, s68, 10
    s_lshl_b32 s23, s68, 9
    s_add_u32 s23, s23, 16384
    v_bfe_u32 v16, v1, 2, 2
    v_and_b32 v17, 3, v1
    v_bfe_u32 v18, v1, 4, 1
    v_lshrrev_b32 v19, 5, v1
    v_lshrrev_b32 v20, 1, v17
    v_and_b32 v21, 1, v17
    v_lshl_or_b32 v20, v21, 1, v20
    v_lshl_add_u32 v21, v19, 3, v16
    v_lshlrev_b32 v21, 7, v21
    v_lshrrev_b32 v22, 1, v16
    s_mul_i32 s74, s71, 56
    v_lshlrev_b32 v23, 5, v18
    v_lshl_add_u32 v23, v20, 3, v23
    v_add_u32 v23, s74, v23
    v_lshlrev_b32 v24, 6, v22
    v_xor_b32 v23, v23, v24
    v_add_u32 v9, v23, v21
    v_lshl_or_b32 v23, v18, 1, v22
    s_lshl_b32 s74, s71, 1
    v_xor_b32 v23, s74, v23
    v_mul_u32_u24 v24, 14336, v18
    v_add_u32 v24, v24, v21
    v_lshl_add_u32 v24, v20, 3, v24
    v_lshl_add_u32 v11, v23, 5, v24
    v_xor_b32 v12, 32, v11
    v_and_b32 v16, 0x13, v1
    v_bfe_u32 v17, v1, 2, 1
    v_lshl_or_b32 v16, v17, 3, v16
    v_bfe_u32 v17, v1, 3, 1
    v_lshl_or_b32 v16, v17, 2, v16
    s_lshl_b32 s74, s72, 5
    v_add_u32 v16, s74, v16
    v_bfe_u32 v17, v16, 1, 3
    v_xor_b32 v17, v17, v19
    v_lshlrev_b32 v16, 7, v16
    v_lshl_add_u32 v16, v17, 4, v16
    v_add_u32 v32, 49152, v16
    v_xor_b32 v33, 32, v32
    v_xor_b32 v34, 64, v32
    v_xor_b32 v35, 96, v32
    v_add_u32 v36, 65536, v32
    v_add_u32 v37, 65536, v33
    v_add_u32 v38, 65536, v34
    v_add_u32 v39, 65536, v35
    s_mov_b32 s48, s34
    s_and_b32 s49, s35, 0xffff
    s_mov_b32 s50, 268435456
    s_mov_b32 s51, 0x00020000
    s_mov_b32 s52, s28
    s_and_b32 s53, s29, 0xffff
    s_mov_b32 s54, 1605632
    s_mov_b32 s55, 0x00020000
    s_mov_b32 s56, s20
    s_and_b32 s57, s21, 0xffff
    s_mov_b32 s58, 401408
    s_mov_b32 s59, 0x00020000
    s_mov_b32 s60, s30
    s_and_b32 s61, s31, 0xffff
    s_mov_b32 s62, 1835008
    s_mov_b32 s63, 0x00020000
    s_cmp_lt_u32 s70, 8
    s_cselect_b32 s12, 0x3e8b97f6, 1.0
    s_lshl1_add_u32 s14, s70, s71
    s_lshl_b32 s14, s14, 17
    s_lshl2_add_u32 s96, s69, s72
    s_mul_i32 s97, s96, 147456
    s_add_u32 s77, s77, s97
    s_lshl_b32 s97, s71, 11
    s_add_u32 s77, s77, s97
    s_add_u32 s77, s77, 8388608
    s_lshl_b32 s96, s96, 11
    s_add_u32 s14, s14, s96
    s_and_b32 s15, s70, 12
    s_lshl1_add_u32 s15, s71, s15
    s_lshl_b32 s15, s15, 17
    s_add_u32 s15, s15, s96
    s_add_u32 s15, s15, 4194304
    v_and_b32 v16, 31, v1
    v_cmp_eq_u32 s[16:17], 28, v16
    v_mov_b32 v245, 0x3f803f80
    s_and_b32 s3, s69, 3
    v_mov_b32 v8, 0xc0135761
    v_mov_b32 v10, 0xbdd2d3e8
    v_mov_b32 v14, 1.0
    v_lshlrev_b32 v6, 4, v1
    v_bfe_u32 v16, v1, 3, 1
    v_lshlrev_b32 v16, 4, v16
    v_bfe_u32 v17, v1, 4, 1
    v_lshl_or_b32 v16, v17, 3, v16
    v_and_b32 v17, 0x27, v1
    v_or_b32 v16, v16, v17
    v_lshlrev_b32 v13, 4, v16
    s_cmp_lt_u32 s70, 8
    s_cselect_b64 s[96:97], -1, 0
    v_cndmask_b32 v13, v13, v6, s[96:97]
    v_cmp_gt_u32 s[96:97], 32, v1
    s_nop 1
    v_cndmask_b32 v7, 0, -1, s[96:97]
    s_cmp_lt_u32 s68, 4
    s_nop 0
    s_cbranch_scc1 L_x0skip2
    buffer_load_dwordx4 v[64:67], v44, s[36:39], s80 offen offset:0
    buffer_load_dwordx4 v[68:71], v44, s[36:39], s80 offen offset:128
    buffer_load_dwordx4 v[72:75], v44, s[36:39], s80 offen offset:256
    buffer_load_dwordx4 v[76:79], v44, s[36:39], s80 offen offset:384
    buffer_load_dwordx4 v[80:83], v44, s[36:39], s80 offen offset:512
    buffer_load_dwordx4 v[84:87], v44, s[36:39], s80 offen offset:640
    buffer_load_dwordx4 v[88:91], v44, s[36:39], s80 offen offset:768
    buffer_load_dwordx4 v[92:95], v44, s[36:39], s81 offen offset:0
    buffer_load_dwordx4 v[96:99], v44, s[36:39], s81 offen offset:128
L_x0skip2:
    v_mov_b32 v16, 0x3f803f80
    v_mov_b32 v17, 0x3f803f80
    v_and_b32 v31, 3, v1
    v_and_b32 v30, 1, v1
    v_lshlrev_b32 v30, 4, v30
    v_mov_b32 v28, 0xffff
    v_lshlrev_b32 v28, v30, v28
    v_cmp_gt_u32 s[84:85], 2, v31
    v_cmp_eq_u32 s[86:87], 0, v30
    s_nop 0
    v_cndmask_b32 v18, 0, v28, s[84:85]
    v_cndmask_b32 v19, v28, 0, s[84:85]
    buffer_load_dwordx4 v[100:103], v44, s[36:39], s81 offen offset:256
    s_waitcnt vmcnt(9)
    v_mfma_f32_4x4x4_16b_bf16 v[128:131], v[16:17], v[64:65], 0
    v_mfma_f32_4x4x4_16b_bf16 v[136:139], v[64:65], v[64:65], 0
    v_mfma_f32_4x4x4_16b_bf16 v[132:135], v[16:17], v[66:67], 0
    v_mfma_f32_4x4x4_16b_bf16 v[140:143], v[66:67], v[66:67], 0
    buffer_load_dwordx4 v[104:107], v44, s[36:39], s81 offen offset:384
    s_waitcnt vmcnt(9)
    v_mfma_f32_4x4x4_16b_bf16 v[128:131], v[16:17], v[68:69], v[128:131]
    v_mfma_f32_4x4x4_16b_bf16 v[136:139], v[68:69], v[68:69], v[136:139]
    v_mfma_f32_4x4x4_16b_bf16 v[132:135], v[16:17], v[70:71], v[132:135]
    v_mfma_f32_4x4x4_16b_bf16 v[140:143], v[70:71], v[70:71], v[140:143]
    buffer_load_dwordx4 v[108:111], v44, s[36:39], s81 offen offset:512
    s_waitcnt vmcnt(9)
    v_mfma_f32_4x4x4_16b_bf16 v[128:131], v[16:17], v[72:73], v[128:131]
    v_mfma_f32_4x4x4_16b_bf16 v[136:139], v[72:73], v[72:73], v[136:139]
    v_mfma_f32_4x4x4_16b_bf16 v[132:135], v[16:17], v[74:75], v[132:135]
    v_mfma_f32_4x4x4_16b_bf16 v[140:143], v[74:75], v[74:75], v[140:143]
    buffer_load_dwordx4 v[112:115], v44, s[36:39], s81 offen offset:640
    s_waitcnt vmcnt(9)
    v_mfma_f32_4x4x4_16b_bf16 v[128:131], v[16:17], v[76:77], v[128:131]
    v_mfma_f32_4x4x4_16b_bf16 v[136:139], v[76:77], v[76:77], v[136:139]
    v_mfma_f32_4x4x4_16b_bf16 v[132:135], v[16:17], v[78:79], v[132:135]
    v_mfma_f32_4x4x4_16b_bf16 v[140:143], v[78:79], v[78:79], v[140:143]
    buffer_load_dwordx4 v[116:119], v44, s[36:39], s81 offen offset:768
    s_waitcnt vmcnt(9)
    v_mfma_f32_4x4x4_16b_bf16 v[128:131], v[16:17], v[80:81], v[128:131]
    v_mfma_f32_4x4x4_16b_bf16 v[136:139], v[80:81], v[80:81], v[136:139]
    v_mfma_f32_4x4x4_16b_bf16 v[132:135], v[16:17], v[82:83], v[132:135]
    v_mfma_f32_4x4x4_16b_bf16 v[140:143], v[82:83], v[82:83], v[140:143]
    s_waitcnt vmcnt(8)
    v_mfma_f32_4x4x4_16b_bf16 v[128:131], v[16:17], v[84:85], v[128:131]
    v_mfma_f32_4x4x4_16b_bf16 v[136:139], v[84:85], v[84:85], v[136:139]
    v_mfma_f32_4x4x4_16b_bf16 v[132:135], v[16:17], v[86:87], v[132:135]
    v_mfma_f32_4x4x4_16b_bf16 v[140:143], v[86:87], v[86:87], v[140:143]
    s_waitcnt vmcnt(7)
    v_mfma_f32_4x4x4_16b_bf16 v[128:131], v[16:17], v[88:89], v[128:131]
    v_mfma_f32_4x4x4_16b_bf16 v[136:139], v[88:89], v[88:89], v[136:139]
    v_mfma_f32_4x4x4_16b_bf16 v[132:135], v[16:17], v[90:91], v[132:135]
    v_mfma_f32_4x4x4_16b_bf16 v[140:143], v[90:91], v[90:91], v[140:143]
    s_nop 3
    v_add_f32 v28, v128, v132
    v_pk_add_f32 v[136:137], v[136:137], v[140:141]
    v_pk_add_f32 v[138:139], v[138:139], v[142:143]
    v_cndmask_b32 v136, v137, v136, s[86:87]
    v_cndmask_b32 v138, v139, v138, s[86:87]
    v_cndmask_b32 v29, v138, v136, s[84:85]
    v_add_f32_dpp v28, v28, v28 quad_perm:[1,0,3,2] row_mask:0xf bank_mask:0xf
    s_nop 0
    v_add_f32_dpp v29, v29, v29 quad_perm:[1,0,3,2] row_mask:0xf bank_mask:0xf
    v_add_f32_dpp v28, v28, v28 quad_perm:[2,3,0,1] row_mask:0xf bank_mask:0xf
    s_nop 0
    v_add_f32_dpp v29, v29, v29 quad_perm:[2,3,0,1] row_mask:0xf bank_mask:0xf
    v_add_f32_dpp v28, v28, v28 row_half_mirror row_mask:0xf bank_mask:0xf
    s_nop 0
    v_add_f32_dpp v29, v29, v29 row_half_mirror row_mask:0xf bank_mask:0xf
    v_mul_f32 v28, 0x3b124925, v28
    v_mul_f32 v29, 0x3b124925, v29
    v_fma_f32 v29, -v28, v28, v29
    v_max_f32 v29, 0, v29
    v_add_f32 v29, 0x3727c5ac, v29
    v_rsq_f32 v30, v29
    s_nop 0
    v_cvt_pk_bf16_f32 v31, v30, v30
    v_mul_f32 v24, -v28, v30
    v_and_b32 v29, 0xffff0000, v31
    v_and_b32 v20, v31, v18
    v_and_b32 v21, v31, v19
    v_sub_f32 v29, v30, v29
    v_cvt_pk_bf16_f32 v31, v29, v29
    v_mov_b32 v25, v24
    v_mov_b32 v26, v24
    v_mov_b32 v27, v24
    v_and_b32 v22, v31, v18
    v_and_b32 v23, v31, v19
    v_mfma_f32_4x4x4_16b_bf16 v[144:147], v[20:21], v[64:65], v[24:27]
    v_mfma_f32_4x4x4_16b_bf16 v[148:151], v[20:21], v[66:67], v[24:27]
    v_mfma_f32_4x4x4_16b_bf16 v[152:155], v[20:21], v[68:69], v[24:27]
    v_mfma_f32_4x4x4_16b_bf16 v[156:159], v[20:21], v[70:71], v[24:27]
    v_mfma_f32_4x4x4_16b_bf16 v[144:147], v[22:23], v[64:65], v[144:147]
    v_mfma_f32_4x4x4_16b_bf16 v[148:151], v[22:23], v[66:67], v[148:151]
    v_mfma_f32_4x4x4_16b_bf16 v[160:163], v[20:21], v[72:73], v[24:27]
    v_mfma_f32_4x4x4_16b_bf16 v[164:167], v[20:21], v[74:75], v[24:27]
    v_mfma_f32_4x4x4_16b_bf16 v[152:155], v[22:23], v[68:69], v[152:155]
    v_mfma_f32_4x4x4_16b_bf16 v[156:159], v[22:23], v[70:71], v[156:159]
    v_mfma_f32_4x4x4_16b_bf16 v[168:171], v[20:21], v[76:77], v[24:27]
    v_cvt_pk_bf16_f32 v64, v144, v145
    v_mfma_f32_4x4x4_16b_bf16 v[172:175], v[20:21], v[78:79], v[24:27]
    v_cvt_pk_bf16_f32 v65, v146, v147
    v_mfma_f32_4x4x4_16b_bf16 v[160:163], v[22:23], v[72:73], v[160:163]
    v_cvt_pk_bf16_f32 v66, v148, v149
    v_mfma_f32_4x4x4_16b_bf16 v[164:167], v[22:23], v[74:75], v[164:167]
    v_cvt_pk_bf16_f32 v67, v150, v151
    ds_write_b128 v40, v[64:67] offset:0
    v_mfma_f32_4x4x4_16b_bf16 v[144:147], v[20:21], v[80:81], v[24:27]
    v_cvt_pk_bf16_f32 v68, v152, v153
    v_mfma_f32_4x4x4_16b_bf16 v[148:151], v[20:21], v[82:83], v[24:27]
    v_cvt_pk_bf16_f32 v69, v154, v155
    v_mfma_f32_4x4x4_16b_bf16 v[168:171], v[22:23], v[76:77], v[168:171]
    v_cvt_pk_bf16_f32 v70, v156, v157
    v_mfma_f32_4x4x4_16b_bf16 v[172:175], v[22:23], v[78:79], v[172:175]
    v_cvt_pk_bf16_f32 v71, v158, v159
    ds_write_b128 v40, v[68:71] offset:16384
    v_mfma_f32_4x4x4_16b_bf16 v[152:155], v[20:21], v[84:85], v[24:27]
    v_cvt_pk_bf16_f32 v72, v160, v161
    v_mfma_f32_4x4x4_16b_bf16 v[156:159], v[20:21], v[86:87], v[24:27]
    v_cvt_pk_bf16_f32 v73, v162, v163
    v_mfma_f32_4x4x4_16b_bf16 v[144:147], v[22:23], v[80:81], v[144:147]
    v_cvt_pk_bf16_f32 v74, v164, v165
    v_mfma_f32_4x4x4_16b_bf16 v[148:151], v[22:23], v[82:83], v[148:151]
    v_cvt_pk_bf16_f32 v75, v166, v167
    ds_write_b128 v40, v[72:75] offset:32768
    v_mfma_f32_4x4x4_16b_bf16 v[160:163], v[20:21], v[88:89], v[24:27]
    v_cvt_pk_bf16_f32 v76, v168, v169
    v_mfma_f32_4x4x4_16b_bf16 v[164:167], v[20:21], v[90:91], v[24:27]
    v_cvt_pk_bf16_f32 v77, v170, v171
    v_mfma_f32_4x4x4_16b_bf16 v[152:155], v[22:23], v[84:85], v[152:155]
    v_cvt_pk_bf16_f32 v78, v172, v173
    v_mfma_f32_4x4x4_16b_bf16 v[156:159], v[22:23], v[86:87], v[156:159]
    v_cvt_pk_bf16_f32 v79, v174, v175
    ds_write_b128 v40, v[76:79] offset:49152
    v_mfma_f32_4x4x4_16b_bf16 v[160:163], v[22:23], v[88:89], v[160:163]
    v_cvt_pk_bf16_f32 v80, v144, v145
    v_mfma_f32_4x4x4_16b_bf16 v[164:167], v[22:23], v[90:91], v[164:167]
    v_cvt_pk_bf16_f32 v81, v146, v147
    v_cvt_pk_bf16_f32 v82, v148, v149
    v_cvt_pk_bf16_f32 v83, v150, v151
    ds_write_b128 v42, v[80:83] offset:0
    v_cvt_pk_bf16_f32 v84, v152, v153
    v_cvt_pk_bf16_f32 v85, v154, v155
    v_cvt_pk_bf16_f32 v86, v156, v157
    v_cvt_pk_bf16_f32 v87, v158, v159
    ds_write_b128 v42, v[84:87] offset:16384
    v_cvt_pk_bf16_f32 v88, v160, v161
    v_cvt_pk_bf16_f32 v89, v162, v163
    v_cvt_pk_bf16_f32 v90, v164, v165
    v_cvt_pk_bf16_f32 v91, v166, v167
    ds_write_b128 v42, v[88:91] offset:32768
    s_waitcnt vmcnt(6)
    v_mfma_f32_4x4x4_16b_bf16 v[128:131], v[16:17], v[92:93], 0
    v_mfma_f32_4x4x4_16b_bf16 v[136:139], v[92:93], v[92:93], 0
    v_mfma_f32_4x4x4_16b_bf16 v[132:135], v[16:17], v[94:95], 0
    v_mfma_f32_4x4x4_16b_bf16 v[140:143], v[94:95], v[94:95], 0
    s_waitcnt vmcnt(5)
    v_mfma_f32_4x4x4_16b_bf16 v[128:131], v[16:17], v[96:97], v[128:131]
    v_mfma_f32_4x4x4_16b_bf16 v[136:139], v[96:97], v[96:97], v[136:139]
    v_mfma_f32_4x4x4_16b_bf16 v[132:135], v[16:17], v[98:99], v[132:135]
    v_mfma_f32_4x4x4_16b_bf16 v[140:143], v[98:99], v[98:99], v[140:143]
    s_waitcnt vmcnt(4)
    v_mfma_f32_4x4x4_16b_bf16 v[128:131], v[16:17], v[100:101], v[128:131]
    v_mfma_f32_4x4x4_16b_bf16 v[136:139], v[100:101], v[100:101], v[136:139]
    v_mfma_f32_4x4x4_16b_bf16 v[132:135], v[16:17], v[102:103], v[132:135]
    v_mfma_f32_4x4x4_16b_bf16 v[140:143], v[102:103], v[102:103], v[140:143]
    s_waitcnt vmcnt(3)
    v_mfma_f32_4x4x4_16b_bf16 v[128:131], v[16:17], v[104:105], v[128:131]
    v_mfma_f32_4x4x4_16b_bf16 v[136:139], v[104:105], v[104:105], v[136:139]
    v_mfma_f32_4x4x4_16b_bf16 v[132:135], v[16:17], v[106:107], v[132:135]
    v_mfma_f32_4x4x4_16b_bf16 v[140:143], v[106:107], v[106:107], v[140:143]
    s_waitcnt vmcnt(2)
    v_mfma_f32_4x4x4_16b_bf16 v[128:131], v[16:17], v[108:109], v[128:131]
    v_mfma_f32_4x4x4_16b_bf16 v[136:139], v[108:109], v[108:109], v[136:139]
    v_mfma_f32_4x4x4_16b_bf16 v[132:135], v[16:17], v[110:111], v[132:135]
    v_mfma_f32_4x4x4_16b_bf16 v[140:143], v[110:111], v[110:111], v[140:143]
    s_waitcnt vmcnt(1)
    v_mfma_f32_4x4x4_16b_bf16 v[128:131], v[16:17], v[112:113], v[128:131]
    v_mfma_f32_4x4x4_16b_bf16 v[136:139], v[112:113], v[112:113], v[136:139]
    v_mfma_f32_4x4x4_16b_bf16 v[132:135], v[16:17], v[114:115], v[132:135]
    v_mfma_f32_4x4x4_16b_bf16 v[140:143], v[114:115], v[114:115], v[140:143]
    s_waitcnt vmcnt(0)
    v_mfma_f32_4x4x4_16b_bf16 v[128:131], v[16:17], v[116:117], v[128:131]
    v_mfma_f32_4x4x4_16b_bf16 v[136:139], v[116:117], v[116:117], v[136:139]
    v_mfma_f32_4x4x4_16b_bf16 v[132:135], v[16:17], v[118:119], v[132:135]
    v_mfma_f32_4x4x4_16b_bf16 v[140:143], v[118:119], v[118:119], v[140:143]
    s_cmp_lg_u32 s71, 0
    s_nop 3
    s_cbranch_scc1 L_nodmaa
    s_add_u32 m0, s22, 0
    s_add_u32 s73, s4, 0
    buffer_load_dwordx4 v2, s[40:43], s73 offen lds
    s_add_u32 m0, s22, 4096
    s_add_u32 s73, s4, 86016
    buffer_load_dwordx4 v2, s[40:43], s73 offen lds
    s_add_u32 m0, s22, 8192
    s_add_u32 s73, s4, 172032
    buffer_load_dwordx4 v2, s[40:43], s73 offen lds
    s_add_u32 m0, s22, 12288
    s_add_u32 s73, s4, 258048
    buffer_load_dwordx4 v2, s[40:43], s73 offen lds
    s_add_u32 m0, s22, 16384
    s_add_u32 s73, s4, 344064
    buffer_load_dwordx4 v2, s[40:43], s73 offen lds
    s_add_u32 m0, s22, 20480
    s_add_u32 s73, s4, 430080
    buffer_load_dwordx4 v2, s[40:43], s73 offen lds
    s_add_u32 m0, s22, 24576
    s_add_u32 s73, s4, 516096
    buffer_load_dwordx4 v2, s[40:43], s73 offen lds
L_nodmaa:
    v_add_f32 v28, v128, v132
    v_pk_add_f32 v[136:137], v[136:137], v[140:141]
    v_pk_add_f32 v[138:139], v[138:139], v[142:143]
    v_cndmask_b32 v136, v137, v136, s[86:87]
    v_cndmask_b32 v138, v139, v138, s[86:87]
    v_cndmask_b32 v29, v138, v136, s[84:85]
    v_add_f32_dpp v28, v28, v28 quad_perm:[1,0,3,2] row_mask:0xf bank_mask:0xf
    s_nop 0
    v_add_f32_dpp v29, v29, v29 quad_perm:[1,0,3,2] row_mask:0xf bank_mask:0xf
    v_add_f32_dpp v28, v28, v28 quad_perm:[2,3,0,1] row_mask:0xf bank_mask:0xf
    s_nop 0
    v_add_f32_dpp v29, v29, v29 quad_perm:[2,3,0,1] row_mask:0xf bank_mask:0xf
    v_add_f32_dpp v28, v28, v28 row_half_mirror row_mask:0xf bank_mask:0xf
    s_nop 0
    v_add_f32_dpp v29, v29, v29 row_half_mirror row_mask:0xf bank_mask:0xf
    v_mul_f32 v28, 0x3b124925, v28
    v_mul_f32 v29, 0x3b124925, v29
    v_fma_f32 v29, -v28, v28, v29
    v_max_f32 v29, 0, v29
    v_add_f32 v29, 0x3727c5ac, v29
    v_rsq_f32 v30, v29
    s_nop 0
    v_cvt_pk_bf16_f32 v31, v30, v30
    v_mul_f32 v24, -v28, v30
    v_and_b32 v29, 0xffff0000, v31
    v_and_b32 v20, v31, v18
    v_and_b32 v21, v31, v19
    v_sub_f32 v29, v30, v29
    v_cvt_pk_bf16_f32 v31, v29, v29
    v_mov_b32 v25, v24
    v_mov_b32 v26, v24
    v_mov_b32 v27, v24
    v_and_b32 v22, v31, v18
    v_and_b32 v23, v31, v19
    v_mfma_f32_4x4x4_16b_bf16 v[144:147], v[20:21], v[92:93], v[24:27]
    v_mfma_f32_4x4x4_16b_bf16 v[148:151], v[20:21], v[94:95], v[24:27]
    v_mfma_f32_4x4x4_16b_bf16 v[152:155], v[20:21], v[96:97], v[24:27]
    v_mfma_f32_4x4x4_16b_bf16 v[156:159], v[20:21], v[98:99], v[24:27]
    v_mfma_f32_4x4x4_16b_bf16 v[144:147], v[22:23], v[92:93], v[144:147]
    v_mfma_f32_4x4x4_16b_bf16 v[148:151], v[22:23], v[94:95], v[148:151]
    v_mfma_f32_4x4x4_16b_bf16 v[160:163], v[20:21], v[100:101], v[24:27]
    v_mfma_f32_4x4x4_16b_bf16 v[164:167], v[20:21], v[102:103], v[24:27]
    v_mfma_f32_4x4x4_16b_bf16 v[152:155], v[22:23], v[96:97], v[152:155]
    v_mfma_f32_4x4x4_16b_bf16 v[156:159], v[22:23], v[98:99], v[156:159]
    v_mfma_f32_4x4x4_16b_bf16 v[168:171], v[20:21], v[104:105], v[24:27]
    v_cvt_pk_bf16_f32 v92, v144, v145
    v_mfma_f32_4x4x4_16b_bf16 v[172:175], v[20:21], v[106:107], v[24:27]
    v_cvt_pk_bf16_f32 v93, v146, v147
    v_mfma_f32_4x4x4_16b_bf16 v[160:163], v[22:23], v[100:101], v[160:163]
    v_cvt_pk_bf16_f32 v94, v148, v149
    v_mfma_f32_4x4x4_16b_bf16 v[164:167], v[22:23], v[102:103], v[164:167]
    v_cvt_pk_bf16_f32 v95, v150, v151
    ds_write_b128 v41, v[92:95] offset:0
    v_mfma_f32_4x4x4_16b_bf16 v[144:147], v[20:21], v[108:109], v[24:27]
    v_cvt_pk_bf16_f32 v96, v152, v153
    v_mfma_f32_4x4x4_16b_bf16 v[148:151], v[20:21], v[110:111], v[24:27]
    v_cvt_pk_bf16_f32 v97, v154, v155
    v_mfma_f32_4x4x4_16b_bf16 v[168:171], v[22:23], v[104:105], v[168:171]
    v_cvt_pk_bf16_f32 v98, v156, v157
    v_mfma_f32_4x4x4_16b_bf16 v[172:175], v[22:23], v[106:107], v[172:175]
    v_cvt_pk_bf16_f32 v99, v158, v159
    ds_write_b128 v41, v[96:99] offset:16384
    v_mfma_f32_4x4x4_16b_bf16 v[152:155], v[20:21], v[112:113], v[24:27]
    v_cvt_pk_bf16_f32 v100, v160, v161
    v_mfma_f32_4x4x4_16b_bf16 v[156:159], v[20:21], v[114:115], v[24:27]
    v_cvt_pk_bf16_f32 v101, v162, v163
    v_mfma_f32_4x4x4_16b_bf16 v[144:147], v[22:23], v[108:109], v[144:147]
    v_cvt_pk_bf16_f32 v102, v164, v165
    v_mfma_f32_4x4x4_16b_bf16 v[148:151], v[22:23], v[110:111], v[148:151]
    v_cvt_pk_bf16_f32 v103, v166, v167
    ds_write_b128 v41, v[100:103] offset:32768
    v_mfma_f32_4x4x4_16b_bf16 v[160:163], v[20:21], v[116:117], v[24:27]
    v_cvt_pk_bf16_f32 v104, v168, v169
    v_mfma_f32_4x4x4_16b_bf16 v[164:167], v[20:21], v[118:119], v[24:27]
    v_cvt_pk_bf16_f32 v105, v170, v171
    v_mfma_f32_4x4x4_16b_bf16 v[152:155], v[22:23], v[112:113], v[152:155]
    v_cvt_pk_bf16_f32 v106, v172, v173
    v_mfma_f32_4x4x4_16b_bf16 v[156:159], v[22:23], v[114:115], v[156:159]
    v_cvt_pk_bf16_f32 v107, v174, v175
    ds_write_b128 v41, v[104:107] offset:49152
    v_mfma_f32_4x4x4_16b_bf16 v[160:163], v[22:23], v[116:117], v[160:163]
    v_cvt_pk_bf16_f32 v108, v144, v145
    v_mfma_f32_4x4x4_16b_bf16 v[164:167], v[22:23], v[118:119], v[164:167]
    v_cvt_pk_bf16_f32 v109, v146, v147
    v_cvt_pk_bf16_f32 v110, v148, v149
    v_cvt_pk_bf16_f32 v111, v150, v151
    ds_write_b128 v43, v[108:111] offset:0
    v_cvt_pk_bf16_f32 v112, v152, v153
    v_cvt_pk_bf16_f32 v113, v154, v155
    v_cvt_pk_bf16_f32 v114, v156, v157
    v_cvt_pk_bf16_f32 v115, v158, v159
    ds_write_b128 v43, v[112:115] offset:16384
    v_cvt_pk_bf16_f32 v116, v160, v161
    v_cvt_pk_bf16_f32 v117, v162, v163
    v_cvt_pk_bf16_f32 v118, v164, v165
    v_cvt_pk_bf16_f32 v119, v166, v167
    ds_write_b128 v43, v[116:119] offset:32768
    s_cmp_lg_u32 s71, 0
    s_cbranch_scc1 L_nodmab
    s_add_u32 m0, s22, 28672
    s_add_u32 s73, s4, 602112
    buffer_load_dwordx4 v2, s[40:43], s73 offen lds
    s_add_u32 m0, s22, 32768
    s_add_u32 s73, s4, 688128
    buffer_load_dwordx4 v2, s[40:43], s73 offen lds
    s_add_u32 m0, s22, 36864
    s_add_u32 s73, s4, 774144
    buffer_load_dwordx4 v2, s[40:43], s73 offen lds
    s_add_u32 m0, s22, 40960
    s_add_u32 s73, s4, 860160
    buffer_load_dwordx4 v2, s[40:43], s73 offen lds
    s_add_u32 m0, s22, 45056
    s_add_u32 s73, s4, 946176
    buffer_load_dwordx4 v2, s[40:43], s73 offen lds
L_nodmab:
    s_lshl2_add_u32 s74, s2, s72
    s_mul_i32 s74, s74, 13
    v_min_u32 v26, 12, v1
    v_add_lshl_u32 v26, v26, s74, 7
    s_mov_b64 exec, 8191
    buffer_load_dword v247, v26, s[44:47], 0 offen
    s_mov_b64 exec, -1
    buffer_store_dwordx2 v[248:249], v246, s[64:67], 0 offen sc1
    s_waitcnt vmcnt(7) lgkmcnt(0)
    s_barrier
    s_cmp_eq_u32 s71, 0
    s_cbranch_scc1 L_noprio
    s_setprio 1
L_noprio:
    s_and_b32 s74, s70, 3
    s_cmp_eq_u32 s74, 3
    s_cbranch_scc1 L_type2
    ds_read_b128 v[128:131], v32 offset:0
    v_add_u32 v4, 0, v9
    ds_read_b64_tr_b16 v[48:49], v4 offset:0
    ds_read_b64_tr_b16 v[50:51], v4 offset:512
    ds_read_b128 v[132:135], v33 offset:0
    ds_read_b64_tr_b16 v[52:53], v4 offset:2048
    ds_read_b64_tr_b16 v[54:55], v4 offset:2560
    ds_read_b128 v[136:139], v34 offset:0
    ds_read_b64_tr_b16 v[56:57], v4 offset:4096
    ds_read_b64_tr_b16 v[58:59], v4 offset:4608
    ds_read_b128 v[140:143], v35 offset:0
    ds_read_b128 v[144:147], v32 offset:16384
    ds_read_b128 v[148:151], v33 offset:16384
    ds_read_b64_tr_b16 v[60:61], v4 offset:6144
    ds_read_b64_tr_b16 v[62:63], v4 offset:6656
    ds_read_b128 v[152:155], v34 offset:16384
    ds_read_b128 v[156:159], v35 offset:16384
    ds_read_b128 v[160:163], v32 offset:32768
    s_waitcnt lgkmcnt(14)
    v_mfma_f32_32x32x16_bf16 v[96:111], v[48:51], v[128:131], 0
    s_and_b32 s96, s2, 7
    s_lshr_b32 s97, s2, 7
    ds_read_b64_tr_b16 v[48:49], v4 offset:8192
    ds_read_b64_tr_b16 v[50:51], v4 offset:8704
    ds_read_b128 v[164:167], v33 offset:32768
    ds_read_b128 v[168:171], v34 offset:32768
    ds_read_b128 v[172:175], v35 offset:32768
    s_waitcnt lgkmcnt(15)
    v_mfma_f32_32x32x16_bf16 v[96:111], v[52:55], v[132:135], v[96:111]
    s_lshl1_add_u32 s18, s96, s97
    s_bfe_u32 s19, s2, 0x40003
    ds_read_b64_tr_b16 v[52:53], v4 offset:10240
    ds_read_b64_tr_b16 v[54:55], v4 offset:10752
    ds_read_b128 v[176:179], v32 offset:49152
    ds_read_b128 v[180:183], v33 offset:49152
    ds_read_b128 v[184:187], v34 offset:49152
    s_waitcnt lgkmcnt(15)
    v_mfma_f32_32x32x16_bf16 v[96:111], v[56:59], v[136:139], v[96:111]
    s_bfe_u32 s97, s2, 0x20003
    s_lshl2_add_u32 s88, s96, s97
    ds_read_b64_tr_b16 v[56:57], v4 offset:12288
    ds_read_b64_tr_b16 v[58:59], v4 offset:12800
    ds_read_b128 v[188:191], v35 offset:49152
    ds_read_b128 v[192:195], v36 offset:0
    ds_read_b128 v[196:199], v37 offset:0
    s_waitcnt lgkmcnt(15)
    v_mfma_f32_32x32x16_bf16 v[96:111], v[60:63], v[140:143], v[96:111]
    s_lshr_b32 s89, s2, 5
    s_lshr_b32 s96, s18, 1
    s_or_b32 s97, s18, 3
    s_waitcnt lgkmcnt(10)
    s_barrier
    s_add_u32 m0, s22, 49152
    s_add_u32 s73, s4, 1032192
    buffer_load_dwordx4 v2, s[40:43], s73 offen lds
    ds_read_b64_tr_b16 v[60:61], v4 offset:14336
    ds_read_b64_tr_b16 v[62:63], v4 offset:14848
    ds_read_b128 v[200:203], v38 offset:0
    ds_read_b128 v[204:207], v39 offset:0
    ds_read_b128 v[208:211], v36 offset:16384
    s_waitcnt lgkmcnt(15)
    v_mfma_f32_32x32x16_bf16 v[96:111], v[48:51], v[144:147], v[96:111]
    s_add_u32 m0, s10, 57344
    s_add_u32 s73, s8, 0
    buffer_load_dwordx4 v3, s[44:47], s73 offen lds
    v_min_u32 v24, 1, v1
    v_sub_u32 v25, v1, v24
    ds_read_b64_tr_b16 v[48:49], v4 offset:16384
    ds_read_b64_tr_b16 v[50:51], v4 offset:16896
    ds_read_b128 v[212:215], v37 offset:16384
    ds_read_b128 v[216:219], v38 offset:16384
    ds_read_b128 v[220:223], v39 offset:16384
    s_waitcnt lgkmcnt(15)
    v_mfma_f32_32x32x16_bf16 v[96:111], v[52:55], v[148:151], v[96:111]
    s_add_u32 m0, s10, 61440
    s_add_u32 s73, s8, 114688
    buffer_load_dwordx4 v3, s[44:47], s73 offen lds
    v_sub_u32 v25, s19, v25
    v_max_i32 v25, 0, v25
    ds_read_b64_tr_b16 v[52:53], v4 offset:18432
    ds_read_b64_tr_b16 v[54:55], v4 offset:18944
    ds_read_b128 v[224:227], v36 offset:32768
    ds_read_b128 v[228:231], v37 offset:32768
    ds_read_b128 v[232:235], v38 offset:32768
    s_waitcnt lgkmcnt(15)
    v_mfma_f32_32x32x16_bf16 v[96:111], v[56:59], v[152:155], v[96:111]
    s_add_u32 m0, s10, 65536
    s_add_u32 s73, s8, 229376
    buffer_load_dwordx4 v3, s[44:47], s73 offen lds
    v_lshl_add_u32 v24, v24, 3, s96
    v_lshl_add_u32 v24, v25, 4, v24
    v_lshlrev_b32 v24, 3, v24
    ds_read_b64_tr_b16 v[56:57], v4 offset:20480
    ds_read_b64_tr_b16 v[58:59], v4 offset:20992
    ds_read_b128 v[236:239], v39 offset:32768
    s_waitcnt lgkmcnt(15)
    v_mfma_f32_32x32x16_bf16 v[96:111], v[60:63], v[156:159], v[96:111]
    s_add_u32 m0, s11, 57344
    s_add_u32 s73, s9, 0
    s_mov_b32 exec_hi, 0
    buffer_load_dwordx4 v3, s[44:47], s73 offen lds
    s_mov_b32 exec_hi, -1
    v_add_u32 v24, 6291456, v24
    v_sub_u32 v25, s19, v1
    ds_read_b64_tr_b16 v[60:61], v4 offset:22528
    ds_read_b64_tr_b16 v[62:63], v4 offset:23040
    s_waitcnt lgkmcnt(13)
    v_mfma_f32_32x32x16_bf16 v[96:111], v[48:51], v[160:163], v[96:111]
    v_max_i32 v25, 0, v25
    v_lshl_add_u32 v25, v25, 4, s97
    ds_read_b64_tr_b16 v[48:49], v4 offset:24576
    ds_read_b64_tr_b16 v[50:51], v4 offset:25088
    s_waitcnt lgkmcnt(10)
    v_mfma_f32_32x32x16_bf16 v[96:111], v[52:55], v[164:167], v[96:111]
    v_lshlrev_b32 v25, 3, v25
    v_add_u32 v25, 6297600, v25
    v_mov_b32 v26, 2147483392
    s_waitcnt vmcnt(7) lgkmcnt(4)
    s_barrier
    ds_read_b64_tr_b16 v[52:53], v4 offset:26624
    ds_read_b64_tr_b16 v[54:55], v4 offset:27136
    s_waitcnt lgkmcnt(7)
    v_mfma_f32_32x32x16_bf16 v[96:111], v[56:59], v[168:171], v[96:111]
    s_add_u32 m0, s10, 86016
    s_add_u32 s73, s8, 401408
    buffer_load_dwordx4 v3, s[44:47], s73 offen lds
    v_cmp_gt_u32 s[96:97], 4, v0
    s_nop 1
    v_cndmask_b32 v253, v26, v24, s[96:97]
    v_add_u32 v4, 28672, v9
    ds_read_b64_tr_b16 v[56:57], v4 offset:0
    ds_read_b64_tr_b16 v[58:59], v4 offset:512
    s_waitcnt lgkmcnt(6)
    v_mfma_f32_32x32x16_bf16 v[96:111], v[60:63], v[172:175], v[96:111]
    s_add_u32 m0, s10, 90112
    s_add_u32 s73, s8, 516096
    buffer_load_dwordx4 v3, s[44:47], s73 offen lds
    v_cndmask_b32 v47, v26, v25, s[96:97]
    s_lshr_b32 s96, s88, 1
    ds_read_b64_tr_b16 v[60:61], v4 offset:2048
    ds_read_b64_tr_b16 v[62:63], v4 offset:2560
    s_waitcnt lgkmcnt(6)
    v_mfma_f32_32x32x16_bf16 v[96:111], v[48:51], v[176:179], v[96:111]
    s_add_u32 m0, s10, 94208
    s_add_u32 s73, s8, 630784
    buffer_load_dwordx4 v3, s[44:47], s73 offen lds
    s_lshl_b32 s96, s96, 7
    s_add_u32 s96, s96, 6293504
    ds_read_b64_tr_b16 v[48:49], v4 offset:4096
    ds_read_b64_tr_b16 v[50:51], v4 offset:4608
    s_waitcnt lgkmcnt(6)
    v_mfma_f32_32x32x16_bf16 v[96:111], v[52:55], v[180:183], v[96:111]
    s_add_u32 m0, s11, 86016
    s_add_u32 s73, s9, 401408
    s_mov_b32 exec_hi, 0
    buffer_load_dwordx4 v3, s[44:47], s73 offen lds
    s_mov_b32 exec_hi, -1
    v_lshl_add_u32 v24, v1, 3, s96
    v_cmp_gt_u32 s[96:97], 16, v0
    s_nop 1
    v_cndmask_b32 v46, v26, v24, s[96:97]
    ds_read_b64_tr_b16 v[52:53], v4 offset:6144
    ds_read_b64_tr_b16 v[54:55], v4 offset:6656
    s_waitcnt lgkmcnt(6)
    v_mfma_f32_32x32x16_bf16 v[96:111], v[56:59], v[184:187], v[96:111]
    s_add_u32 m0, s10, 114688
    s_add_u32 s73, s8, 802816
    buffer_load_dwordx4 v3, s[44:47], s73 offen lds
    s_lshl4_add_u32 s20, s69, s70
    s_lshl_b32 s20, s20, 3
    ds_read_b64_tr_b16 v[56:57], v4 offset:8192
    ds_read_b64_tr_b16 v[58:59], v4 offset:8704
    s_waitcnt lgkmcnt(6)
    v_mfma_f32_32x32x16_bf16 v[96:111], v[60:63], v[188:191], v[96:111]
    s_add_u32 m0, s10, 118784
    s_add_u32 s73, s8, 917504
    buffer_load_dwordx4 v3, s[44:47], s73 offen lds
    s_add_u32 s20, s20, 6291456
    s_lshl4_add_u32 s80, s19, s18
    ds_read_b64_tr_b16 v[60:61], v4 offset:10240
    ds_read_b64_tr_b16 v[62:63], v4 offset:10752
    s_waitcnt lgkmcnt(6)
    v_mfma_f32_32x32x16_bf16 v[96:111], v[48:51], v[192:195], v[96:111]
    s_add_u32 m0, s10, 122880
    s_add_u32 s73, s8, 1032192
    buffer_load_dwordx4 v3, s[44:47], s73 offen lds
    s_lshl_b32 s80, s80, 3
    s_add_u32 s80, s80, 6291456
    s_lshl_b32 s84, s18, 17
    ds_read_b64_tr_b16 v[48:49], v4 offset:12288
    ds_read_b64_tr_b16 v[50:51], v4 offset:12800
    s_waitcnt lgkmcnt(6)
    v_mfma_f32_32x32x16_bf16 v[96:111], v[52:55], v[196:199], v[96:111]
    s_add_u32 m0, s11, 114688
    s_add_u32 s73, s9, 802816
    s_mov_b32 exec_hi, 0
    buffer_load_dwordx4 v3, s[44:47], s73 offen lds
    s_mov_b32 exec_hi, -1
    s_lshl_b32 s96, s19, 13
    s_mul_i32 s97, s68, 3072
    ds_read_b64_tr_b16 v[52:53], v4 offset:14336
    ds_read_b64_tr_b16 v[54:55], v4 offset:14848
    s_waitcnt lgkmcnt(6)
    v_mfma_f32_32x32x16_bf16 v[96:111], v[56:59], v[200:203], v[96:111]
    buffer_load_dwordx2 v[248:249], v251, s[64:67], 0 offen sc1
    s_add_u32 s97, s97, s96
    s_sub_u32 s81, s97, 16384
    ds_read_b64_tr_b16 v[56:57], v4 offset:16384
    ds_read_b64_tr_b16 v[58:59], v4 offset:16896
    s_waitcnt lgkmcnt(6)
    v_mfma_f32_32x32x16_bf16 v[96:111], v[60:63], v[204:207], v[96:111]
    s_max_i32 s81, s81, 0
    s_add_u32 s81, s81, s84
    s_sub_u32 s82, s97, 15360
    s_waitcnt vmcnt(13)
    s_barrier
    ds_read_b64_tr_b16 v[60:61], v4 offset:18432
    ds_read_b64_tr_b16 v[62:63], v4 offset:18944
    s_waitcnt lgkmcnt(6)
    v_mfma_f32_32x32x16_bf16 v[96:111], v[48:51], v[208:211], v[96:111]
    s_max_i32 s82, s82, 0
    s_add_u32 s82, s82, s84
    ds_read_b64_tr_b16 v[48:49], v4 offset:20480
    ds_read_b64_tr_b16 v[50:51], v4 offset:20992
    s_waitcnt lgkmcnt(6)
    v_mfma_f32_32x32x16_bf16 v[96:111], v[52:55], v[212:215], v[96:111]
    s_sub_u32 s83, s97, 14336
    s_max_i32 s83, s83, 0
    ds_read_b64_tr_b16 v[52:53], v4 offset:22528
    ds_read_b64_tr_b16 v[54:55], v4 offset:23040
    s_waitcnt lgkmcnt(6)
    v_mfma_f32_32x32x16_bf16 v[96:111], v[56:59], v[216:219], v[96:111]
    s_add_u32 s83, s83, s84
    s_add_u32 s84, s84, s96
    v_and_b32 v24, 15, v1
    ds_read_b64_tr_b16 v[56:57], v4 offset:24576
    ds_read_b64_tr_b16 v[58:59], v4 offset:25088
    s_waitcnt lgkmcnt(6)
    v_mfma_f32_32x32x16_bf16 v[96:111], v[60:63], v[220:223], v[96:111]
    v_lshrrev_b32 v25, 4, v1
    v_lshlrev_b32 v244, 9, v25
    s_waitcnt vmcnt(9)
    s_barrier
    ds_read_b64_tr_b16 v[60:61], v4 offset:26624
    ds_read_b64_tr_b16 v[62:63], v4 offset:27136
    s_waitcnt lgkmcnt(6)
    v_mfma_f32_32x32x16_bf16 v[96:111], v[48:51], v[224:227], v[96:111]
    s_add_u32 m0, s10, 0
    s_add_u32 s73, s8, 1204224
    buffer_load_dwordx4 v3, s[44:47], s73 offen lds
    v_lshl_add_u32 v244, v24, 4, v244
    s_and_b32 s92, s68, 1
    v_add_u32 v4, 57344, v11
    v_add_u32 v5, 57344, v12
    ds_read_b64_tr_b16 v[48:49], v4 offset:0
    ds_read_b64_tr_b16 v[50:51], v4 offset:512
    s_waitcnt lgkmcnt(6)
    v_mfma_f32_32x32x16_bf16 v[96:111], v[52:55], v[228:231], v[96:111]
    s_add_u32 m0, s10, 4096
    s_add_u32 s73, s8, 1318912
    buffer_load_dwordx4 v3, s[44:47], s73 offen lds
    s_lshl_b32 s85, s92, 8
    s_lshr_b32 s86, s68, 1
    ds_read_b64_tr_b16 v[52:53], v5 offset:0
    ds_read_b64_tr_b16 v[54:55], v5 offset:512
    s_waitcnt lgkmcnt(6)
    v_mfma_f32_32x32x16_bf16 v[96:111], v[56:59], v[232:235], v[96:111]
    s_add_u32 m0, s10, 8192
    s_add_u32 s73, s8, 1433600
    buffer_load_dwordx4 v3, s[44:47], s73 offen lds
    s_lshl2_add_u32 s86, s19, s86
    ds_read_b64_tr_b16 v[56:57], v4 offset:2048
    ds_read_b64_tr_b16 v[58:59], v4 offset:2560
    s_waitcnt lgkmcnt(6)
    v_mfma_f32_32x32x16_bf16 v[96:111], v[60:63], v[236:239], v[96:111]
    s_add_u32 m0, s11, 0
    s_add_u32 s73, s9, 1204224
    s_mov_b32 exec_hi, 0
    buffer_load_dwordx4 v3, s[44:47], s73 offen lds
    s_mov_b32 exec_hi, -1
    ds_read_b64_tr_b16 v[60:61], v5 offset:2048
    ds_read_b64_tr_b16 v[62:63], v5 offset:2560
    s_waitcnt lgkmcnt(6)
    v_mfma_f32_32x32x16_bf16 v[64:79], v[48:51], v[128:131], 0
    ds_read_b64_tr_b16 v[48:49], v4 offset:4096
    ds_read_b64_tr_b16 v[50:51], v4 offset:4608
    s_waitcnt lgkmcnt(6)
    v_mfma_f32_32x32x16_bf16 v[80:95], v[52:55], v[128:131], 0
    ds_read_b64_tr_b16 v[52:53], v5 offset:4096
    ds_read_b64_tr_b16 v[54:55], v5 offset:4608
    s_waitcnt lgkmcnt(6)
    v_mfma_f32_32x32x16_bf16 v[64:79], v[56:59], v[132:135], v[64:79]
    v_mul_f32 v96, s12, v96
    v_mul_f32 v97, s12, v97
    ds_read_b64_tr_b16 v[56:57], v4 offset:6144
    ds_read_b64_tr_b16 v[58:59], v4 offset:6656
    s_waitcnt lgkmcnt(6)
    v_mfma_f32_32x32x16_bf16 v[80:95], v[60:63], v[132:135], v[80:95]
    v_mul_f32 v98, s12, v98
    v_mul_f32 v99, s12, v99
    ds_read_b64_tr_b16 v[60:61], v5 offset:6144
    ds_read_b64_tr_b16 v[62:63], v5 offset:6656
    s_waitcnt lgkmcnt(6)
    v_mfma_f32_32x32x16_bf16 v[64:79], v[48:51], v[136:139], v[64:79]
    v_mul_f32 v100, s12, v100
    v_mul_f32 v101, s12, v101
    ds_read_b64_tr_b16 v[48:49], v4 offset:8192
    ds_read_b64_tr_b16 v[50:51], v4 offset:8704
    s_waitcnt lgkmcnt(6)
    v_mfma_f32_32x32x16_bf16 v[80:95], v[52:55], v[136:139], v[80:95]
    v_mul_f32 v102, s12, v102
    v_mul_f32 v103, s12, v103
    ds_read_b64_tr_b16 v[52:53], v5 offset:8192
    ds_read_b64_tr_b16 v[54:55], v5 offset:8704
    s_waitcnt lgkmcnt(6)
    v_mfma_f32_32x32x16_bf16 v[64:79], v[56:59], v[140:143], v[64:79]
    v_mul_f32 v104, s12, v104
    v_mul_f32 v105, s12, v105
    ds_read_b64_tr_b16 v[56:57], v4 offset:10240
    ds_read_b64_tr_b16 v[58:59], v4 offset:10752
    s_waitcnt lgkmcnt(6)
    v_mfma_f32_32x32x16_bf16 v[80:95], v[60:63], v[140:143], v[80:95]
    v_mul_f32 v106, s12, v106
    v_mul_f32 v107, s12, v107
    s_waitcnt vmcnt(9)
    s_barrier
    ds_read_b64_tr_b16 v[60:61], v5 offset:10240
    ds_read_b64_tr_b16 v[62:63], v5 offset:10752
    s_waitcnt lgkmcnt(6)
    v_mfma_f32_32x32x16_bf16 v[64:79], v[48:51], v[144:147], v[64:79]
    s_add_u32 m0, s10, 28672
    s_add_u32 s73, s8, 128
    buffer_load_dwordx4 v3, s[44:47], s73 offen lds
    v_mul_f32 v108, s12, v108
    v_mul_f32 v109, s12, v109
    ds_read_b64_tr_b16 v[48:49], v4 offset:12288
    ds_read_b64_tr_b16 v[50:51], v4 offset:12800
    s_waitcnt lgkmcnt(6)
    v_mfma_f32_32x32x16_bf16 v[80:95], v[52:55], v[144:147], v[80:95]
    s_add_u32 m0, s10, 32768
    s_add_u32 s73, s8, 114816
    buffer_load_dwordx4 v3, s[44:47], s73 offen lds
    v_mul_f32 v110, s12, v110
    v_mul_f32 v111, s12, v111
    ds_read_b64_tr_b16 v[52:53], v5 offset:12288
    ds_read_b64_tr_b16 v[54:55], v5 offset:12800
    s_waitcnt lgkmcnt(6)
    v_mfma_f32_32x32x16_bf16 v[64:79], v[56:59], v[148:151], v[64:79]
    s_add_u32 m0, s10, 36864
    s_add_u32 s73, s8, 229504
    buffer_load_dwordx4 v3, s[44:47], s73 offen lds
    v_cvt_pk_bf16_f32 v16, v96, v97
    v_cvt_pk_bf16_f32 v17, v98, v99
    v_add_u32 v4, 86016, v11
    v_add_u32 v5, 86016, v12
    ds_read_b64_tr_b16 v[56:57], v4 offset:0
    ds_read_b64_tr_b16 v[58:59], v4 offset:512
    s_waitcnt lgkmcnt(6)
    v_mfma_f32_32x32x16_bf16 v[80:95], v[60:63], v[148:151], v[80:95]
    s_add_u32 m0, s11, 28672
    s_add_u32 s73, s9, 128
    s_mov_b32 exec_hi, 0
    buffer_load_dwordx4 v3, s[44:47], s73 offen lds
    s_mov_b32 exec_hi, -1
    v_cvt_pk_bf16_f32 v18, v100, v101
    v_cvt_pk_bf16_f32 v19, v102, v103
    ds_read_b64_tr_b16 v[60:61], v5 offset:0
    ds_read_b64_tr_b16 v[62:63], v5 offset:512
    s_waitcnt lgkmcnt(6)
    v_mfma_f32_32x32x16_bf16 v[64:79], v[48:51], v[152:155], v[64:79]
    v_cvt_pk_bf16_f32 v20, v104, v105
    v_cvt_pk_bf16_f32 v21, v106, v107
    ds_read_b64_tr_b16 v[48:49], v4 offset:2048
    ds_read_b64_tr_b16 v[50:51], v4 offset:2560
    s_waitcnt lgkmcnt(6)
    v_mfma_f32_32x32x16_bf16 v[80:95], v[52:55], v[152:155], v[80:95]
    v_cvt_pk_bf16_f32 v22, v108, v109
    v_cvt_pk_bf16_f32 v23, v110, v111
    ds_read_b64_tr_b16 v[52:53], v5 offset:2048
    ds_read_b64_tr_b16 v[54:55], v5 offset:2560
    s_waitcnt lgkmcnt(6)
    v_mfma_f32_32x32x16_bf16 v[64:79], v[56:59], v[156:159], v[64:79]
    v_and_b32 v22, v22, v7
    v_and_b32 v23, v23, v7
    s_mul_i32 s87, s86, 147456
    ds_read_b64_tr_b16 v[56:57], v4 offset:4096
    ds_read_b64_tr_b16 v[58:59], v4 offset:4608
    s_waitcnt lgkmcnt(6)
    v_mfma_f32_32x32x16_bf16 v[80:95], v[60:63], v[156:159], v[80:95]
    s_lshl_b32 s96, s18, 11
    s_add_u32 s87, s87, s96
    buffer_store_dwordx4 v[16:19], v13, s[48:51], s14 offen sc1
    buffer_store_dwordx4 v[20:23], v13, s[48:51], s14 offen offset:1024 sc1
    ds_read_b64_tr_b16 v[60:61], v5 offset:4096
    ds_read_b64_tr_b16 v[62:63], v5 offset:4608
    s_waitcnt lgkmcnt(6)
    v_mfma_f32_32x32x16_bf16 v[64:79], v[48:51], v[160:163], v[64:79]
    s_add_u32 s87, s87, s85
    s_add_u32 s87, s87, 8503296
    ds_read_b64_tr_b16 v[48:49], v4 offset:6144
    ds_read_b64_tr_b16 v[50:51], v4 offset:6656
    s_waitcnt lgkmcnt(6)
    v_mfma_f32_32x32x16_bf16 v[80:95], v[52:55], v[160:163], v[80:95]
    v_and_b32 v45, 3, v1
    v_bfe_u32 v24, v1, 2, 1
    ds_read_b64_tr_b16 v[52:53], v5 offset:6144
    ds_read_b64_tr_b16 v[54:55], v5 offset:6656
    s_waitcnt lgkmcnt(6)
    v_mfma_f32_32x32x16_bf16 v[64:79], v[56:59], v[164:167], v[64:79]
    v_lshl_or_b32 v45, v24, 3, v45
    v_bfe_u32 v24, v1, 3, 1
    ds_read_b64_tr_b16 v[56:57], v4 offset:8192
    ds_read_b64_tr_b16 v[58:59], v4 offset:8704
    s_waitcnt lgkmcnt(6)
    v_mfma_f32_32x32x16_bf16 v[80:95], v[60:63], v[164:167], v[80:95]
    v_lshl_or_b32 v45, v24, 2, v45
    s_lshl_b32 s96, s92, 4
    ds_read_b64_tr_b16 v[60:61], v5 offset:8192
    ds_read_b64_tr_b16 v[62:63], v5 offset:8704
    s_waitcnt lgkmcnt(6)
    v_mfma_f32_32x32x16_bf16 v[64:79], v[48:51], v[168:171], v[64:79]
    v_add_u32 v45, s96, v45
    v_lshlrev_b32 v24, 3, v25
    ds_read_b64_tr_b16 v[48:49], v4 offset:10240
    ds_read_b64_tr_b16 v[50:51], v4 offset:10752
    s_waitcnt lgkmcnt(6)
    v_mfma_f32_32x32x16_bf16 v[80:95], v[52:55], v[168:171], v[80:95]
    v_sub_u32 v45, v45, v24
    s_lshr_b32 s90, s68, 2
    s_waitcnt vmcnt(11)
    s_barrier
    ds_read_b64_tr_b16 v[52:53], v5 offset:10240
    ds_read_b64_tr_b16 v[54:55], v5 offset:10752
    s_waitcnt lgkmcnt(6)
    v_mfma_f32_32x32x16_bf16 v[64:79], v[56:59], v[172:175], v[64:79]
    s_add_u32 m0, s10, 57344
    s_add_u32 s73, s8, 401536
    buffer_load_dwordx4 v3, s[44:47], s73 offen lds
    s_bfe_u32 s91, s68, 0x10001
    v_lshrrev_b32 v24, 3, v1
    ds_read_b64_tr_b16 v[56:57], v4 offset:12288
    ds_read_b64_tr_b16 v[58:59], v4 offset:12800
    s_waitcnt lgkmcnt(6)
    v_mfma_f32_32x32x16_bf16 v[80:95], v[60:63], v[172:175], v[80:95]
    s_add_u32 m0, s10, 61440
    s_add_u32 s73, s8, 516224
    buffer_load_dwordx4 v3, s[44:47], s73 offen lds
    v_and_b32 v25, 7, v1
    v_bfe_u32 v26, v1, 4, 1
    ds_read_b64_tr_b16 v[60:61], v5 offset:12288
    ds_read_b64_tr_b16 v[62:63], v5 offset:12800
    s_waitcnt lgkmcnt(6)
    v_mfma_f32_32x32x16_bf16 v[64:79], v[48:51], v[176:179], v[64:79]
    s_add_u32 m0, s10, 65536
    s_add_u32 s73, s8, 630912
    buffer_load_dwordx4 v3, s[44:47], s73 offen lds
    v_lshlrev_b32 v27, 2, v26
    v_xor_b32 v27, v27, v25
    v_add_u32 v4, 114688, v11
    v_add_u32 v5, 114688, v12
    ds_read_b64_tr_b16 v[48:49], v4 offset:0
    ds_read_b64_tr_b16 v[50:51], v4 offset:512
    s_waitcnt lgkmcnt(6)
    v_mfma_f32_32x32x16_bf16 v[80:95], v[52:55], v[176:179], v[80:95]
    s_add_u32 m0, s11, 57344
    s_add_u32 s73, s9, 401536
    s_mov_b32 exec_hi, 0
    buffer_load_dwordx4 v3, s[44:47], s73 offen lds
    s_mov_b32 exec_hi, -1
    v_mul_u32_u24 v44, 896, v24
    v_lshl_add_u32 v44, v27, 4, v44
    ds_read_b64_tr_b16 v[52:53], v5 offset:0
    ds_read_b64_tr_b16 v[54:55], v5 offset:512
    s_waitcnt lgkmcnt(6)
    v_mfma_f32_32x32x16_bf16 v[64:79], v[56:59], v[180:183], v[64:79]
    s_lshl_b32 s29, s68, 11
    s_add_u32 s30, s29, 65536
    ds_read_b64_tr_b16 v[56:57], v4 offset:2048
    ds_read_b64_tr_b16 v[58:59], v4 offset:2560
    s_waitcnt lgkmcnt(6)
    v_mfma_f32_32x32x16_bf16 v[80:95], v[60:63], v[180:183], v[80:95]
    s_mul_i32 s95, s68, 14336
    s_lshl_b32 s96, s89, 7
    s_add_u32 s95, s95, s96
    ds_read_b64_tr_b16 v[60:61], v5 offset:2048
    ds_read_b64_tr_b16 v[62:63], v5 offset:2560
    s_waitcnt lgkmcnt(6)
    v_mfma_f32_32x32x16_bf16 v[64:79], v[48:51], v[184:187], v[64:79]
    s_lshr_b32 s28, s68, 1
    s_mul_i32 s28, s28, 28
    ds_read_b64_tr_b16 v[48:49], v4 offset:4096
    ds_read_b64_tr_b16 v[50:51], v4 offset:4608
    s_waitcnt lgkmcnt(6)
    v_mfma_f32_32x32x16_bf16 v[80:95], v[52:55], v[184:187], v[80:95]
    s_lshl4_add_u32 s28, s92, s28
    s_mul_i32 s28, s28, 896
    ds_read_b64_tr_b16 v[52:53], v5 offset:4096
    ds_read_b64_tr_b16 v[54:55], v5 offset:4608
    s_waitcnt lgkmcnt(6)
    v_mfma_f32_32x32x16_bf16 v[64:79], v[56:59], v[188:191], v[64:79]
    s_add_u32 s28, s28, s96
    s_lshl1_add_u32 s97, s88, s91
    ds_read_b64_tr_b16 v[56:57], v4 offset:6144
    ds_read_b64_tr_b16 v[58:59], v4 offset:6656
    s_waitcnt lgkmcnt(6)
    v_mfma_f32_32x32x16_bf16 v[80:95], v[60:63], v[188:191], v[80:95]
    s_mul_i32 s31, s97, 28672
    s_add_u32 s31, s31, s96
    s_lshl3_add_u32 s74, s2, s68
    s_mul_i32 s74, s74, 7
    v_min_u32 v246, 6, v1
    v_add_lshl_u32 v246, v246, s74, 7
    s_mov_b64 exec, 127
    buffer_load_dword v247, v246, s[52:55], 0 offen
    s_mov_b64 exec, -1
    s_lshl3_add_u32 s74, s2, s68
    s_mul_i32 s74, s74, 2
    v_min_u32 v246, 1, v1
    v_add_lshl_u32 v246, v246, s74, 7
    s_mov_b64 exec, 3
    buffer_load_dword v247, v246, s[56:59], 0 offen
    s_mov_b64 exec, -1
    ds_read_b64_tr_b16 v[60:61], v5 offset:6144
    ds_read_b64_tr_b16 v[62:63], v5 offset:6656
    s_waitcnt lgkmcnt(6)
    v_mfma_f32_32x32x16_bf16 v[64:79], v[48:51], v[192:195], v[64:79]
    s_lshl_b32 s96, s92, 6
    s_add_u32 s31, s31, s96
    ds_read_b64_tr_b16 v[48:49], v4 offset:8192
    ds_read_b64_tr_b16 v[50:51], v4 offset:8704
    s_waitcnt lgkmcnt(6)
    v_mfma_f32_32x32x16_bf16 v[80:95], v[52:55], v[192:195], v[80:95]
    s_lshl_b32 s96, s90, 5
    s_add_u32 s31, s31, s96
    ds_read_b64_tr_b16 v[52:53], v5 offset:8192
    ds_read_b64_tr_b16 v[54:55], v5 offset:8704
    s_waitcnt lgkmcnt(6)
    v_mfma_f32_32x32x16_bf16 v[64:79], v[56:59], v[196:199], v[64:79]
    s_lshl_b32 s96, s89, 2
    s_lshr_b32 s96, 0x0, s96
    ds_read_b64_tr_b16 v[56:57], v4 offset:10240
    ds_read_b64_tr_b16 v[58:59], v4 offset:10752
    s_waitcnt lgkmcnt(6)
    v_mfma_f32_32x32x16_bf16 v[80:95], v[60:63], v[196:199], v[80:95]
    s_and_b32 s96, s96, 15
    s_lshl_b32 s94, s96, 13
    s_waitcnt vmcnt(12)
    s_barrier
    s_mov_b32 s76, 0
    s_nop 6
L_nz0:
    v_readfirstlane_b32 s75, v248
    s_nop 0
    s_cmp_lg_u32 s75, 0
    s_nop 2
    s_cbranch_scc1 L_nz_done0
    s_add_u32 s76, s76, 1
    s_cmp_gt_u32 s76, 100000
    s_cbranch_scc1 L_nz_done0
    s_sleep 2
    buffer_load_dwordx2 v[248:249], v251, s[64:67], 0 offen sc1
    s_waitcnt vmcnt(0)
    s_branch L_nz0
L_nz_done0:
    ds_read_b64_tr_b16 v[60:61], v5 offset:10240
    ds_read_b64_tr_b16 v[62:63], v5 offset:10752
    s_waitcnt lgkmcnt(6)
    v_mfma_f32_32x32x16_bf16 v[64:79], v[48:51], v[200:203], v[64:79]
    s_add_u32 m0, s10, 86016
    s_add_u32 s73, s8, 802944
    buffer_load_dwordx4 v3, s[44:47], s73 offen lds
    s_mul_i32 s96, s96, 114688
    s_add_u32 s95, s95, s96
    ds_read_b64_tr_b16 v[48:49], v4 offset:12288
    ds_read_b64_tr_b16 v[50:51], v4 offset:12800
    s_waitcnt lgkmcnt(6)
    v_mfma_f32_32x32x16_bf16 v[80:95], v[52:55], v[200:203], v[80:95]
    s_add_u32 m0, s10, 90112
    s_add_u32 s73, s8, 917632
    buffer_load_dwordx4 v3, s[44:47], s73 offen lds
    s_and_b32 s96, s88, 3
    s_lshl_b32 s97, s96, 2
    ds_read_b64_tr_b16 v[52:53], v5 offset:12288
    ds_read_b64_tr_b16 v[54:55], v5 offset:12800
    s_waitcnt lgkmcnt(6)
    v_mfma_f32_32x32x16_bf16 v[64:79], v[56:59], v[204:207], v[64:79]
    s_add_u32 m0, s10, 94208
    s_add_u32 s73, s8, 1032320
    buffer_load_dwordx4 v3, s[44:47], s73 offen lds
    s_lshr_b32 s97, 0x0, s97
    s_and_b32 s97, s97, 15
    v_add_u32 v4, 0, v11
    v_add_u32 v5, 0, v12
    ds_read_b64_tr_b16 v[56:57], v4 offset:0
    ds_read_b64_tr_b16 v[58:59], v4 offset:512
    s_waitcnt lgkmcnt(6)
    v_mfma_f32_32x32x16_bf16 v[80:95], v[60:63], v[204:207], v[80:95]
    s_add_u32 m0, s11, 86016
    s_add_u32 s73, s9, 802944
    s_mov_b32 exec_hi, 0
    buffer_load_dwordx4 v3, s[44:47], s73 offen lds
    s_mov_b32 exec_hi, -1
    s_mul_i32 s97, s97, 896
    s_add_u32 s96, s96, s97
    ds_read_b64_tr_b16 v[60:61], v5 offset:0
    ds_read_b64_tr_b16 v[62:63], v5 offset:512
    s_waitcnt lgkmcnt(6)
    v_mfma_f32_32x32x16_bf16 v[64:79], v[48:51], v[208:211], v[64:79]
    s_lshl_b32 s96, s96, 7
    s_mul_i32 s97, s68, 14336
    s_add_u32 s96, s96, s97
    ds_read_b64_tr_b16 v[48:49], v4 offset:2048
    ds_read_b64_tr_b16 v[50:51], v4 offset:2560
    s_waitcnt lgkmcnt(6)
    v_mfma_f32_32x32x16_bf16 v[80:95], v[52:55], v[208:211], v[80:95]
    s_add_u32 s96, s96, 688128
    s_cmp_ge_u32 s89, 7
    s_cselect_b32 s95, s96, s95
    ds_read_b64_tr_b16 v[52:53], v5 offset:2048
    ds_read_b64_tr_b16 v[54:55], v5 offset:2560
    s_waitcnt lgkmcnt(6)
    v_mfma_f32_32x32x16_bf16 v[64:79], v[56:59], v[212:215], v[64:79]
    s_lshl1_add_u32 s93, s88, s90
    s_mul_i32 s93, s93, 147456
    ds_read_b64_tr_b16 v[56:57], v4 offset:4096
    ds_read_b64_tr_b16 v[58:59], v4 offset:4608
    s_waitcnt lgkmcnt(6)
    v_mfma_f32_32x32x16_bf16 v[80:95], v[60:63], v[212:215], v[80:95]
    s_lshl_b32 s96, s72, 11
    s_add_u32 s93, s93, s96
    ds_read_b64_tr_b16 v[60:61], v5 offset:4096
    ds_read_b64_tr_b16 v[62:63], v5 offset:4608
    s_waitcnt lgkmcnt(6)
    v_mfma_f32_32x32x16_bf16 v[64:79], v[48:51], v[216:219], v[64:79]
    s_add_u32 s93, s93, 8388608
    ds_read_b64_tr_b16 v[48:49], v4 offset:6144
    ds_read_b64_tr_b16 v[50:51], v4 offset:6656
    s_waitcnt lgkmcnt(6)
    v_mfma_f32_32x32x16_bf16 v[80:95], v[52:55], v[216:219], v[80:95]
    ds_read_b64_tr_b16 v[52:53], v5 offset:6144
    ds_read_b64_tr_b16 v[54:55], v5 offset:6656
    s_waitcnt lgkmcnt(6)
    v_mfma_f32_32x32x16_bf16 v[64:79], v[56:59], v[220:223], v[64:79]
    ds_read_b64_tr_b16 v[56:57], v4 offset:8192
    ds_read_b64_tr_b16 v[58:59], v4 offset:8704
    s_waitcnt lgkmcnt(6)
    v_mfma_f32_32x32x16_bf16 v[80:95], v[60:63], v[220:223], v[80:95]
    ds_read_b64_tr_b16 v[60:61], v5 offset:8192
    ds_read_b64_tr_b16 v[62:63], v5 offset:8704
    s_waitcnt lgkmcnt(6)
    v_mfma_f32_32x32x16_bf16 v[64:79], v[48:51], v[224:227], v[64:79]
    ds_read_b64_tr_b16 v[48:49], v4 offset:10240
    ds_read_b64_tr_b16 v[50:51], v4 offset:10752
    s_waitcnt lgkmcnt(6)
    v_mfma_f32_32x32x16_bf16 v[80:95], v[52:55], v[224:227], v[80:95]
    s_waitcnt vmcnt(10)
    s_barrier
    s_add_u32 s75, s20, 0
    buffer_store_dwordx2 v[248:249], v252, s[48:51], s75 offen sc1
    ds_read_b64_tr_b16 v[52:53], v5 offset:10240
    ds_read_b64_tr_b16 v[54:55], v5 offset:10752
    s_waitcnt lgkmcnt(6)
    v_mfma_f32_32x32x16_bf16 v[64:79], v[56:59], v[228:231], v[64:79]
    s_add_u32 m0, s10, 114688
    s_add_u32 s73, s8, 1204352
    buffer_load_dwordx4 v3, s[44:47], s73 offen lds
    ds_read_b64_tr_b16 v[56:57], v4 offset:12288
    ds_read_b64_tr_b16 v[58:59], v4 offset:12800
    s_waitcnt lgkmcnt(6)
    v_mfma_f32_32x32x16_bf16 v[80:95], v[60:63], v[228:231], v[80:95]
    s_add_u32 m0, s10, 118784
    s_add_u32 s73, s8, 1319040
    buffer_load_dwordx4 v3, s[44:47], s73 offen lds
    ds_read_b64_tr_b16 v[60:61], v5 offset:12288
    ds_read_b64_tr_b16 v[62:63], v5 offset:12800
    s_waitcnt lgkmcnt(6)
    v_mfma_f32_32x32x16_bf16 v[64:79], v[48:51], v[232:235], v[64:79]
    s_add_u32 m0, s10, 122880
    s_add_u32 s73, s8, 1433728
    buffer_load_dwordx4 v3, s[44:47], s73 offen lds
    v_add_u32 v4, 28672, v11
    ds_read_b64_tr_b16 v[48:49], v4 offset:0
    ds_read_b64_tr_b16 v[50:51], v4 offset:512
    s_waitcnt lgkmcnt(6)
    v_mfma_f32_32x32x16_bf16 v[80:95], v[52:55], v[232:235], v[80:95]
    s_add_u32 m0, s11, 114688
    s_add_u32 s73, s9, 1204352
    s_mov_b32 exec_hi, 0
    buffer_load_dwordx4 v3, s[44:47], s73 offen lds
    s_mov_b32 exec_hi, -1
    ds_read_b64_tr_b16 v[52:53], v4 offset:2048
    ds_read_b64_tr_b16 v[54:55], v4 offset:2560
    s_waitcnt lgkmcnt(6)
    v_mfma_f32_32x32x16_bf16 v[64:79], v[56:59], v[236:239], v[64:79]
    ds_read_b64_tr_b16 v[56:57], v4 offset:4096
    ds_read_b64_tr_b16 v[58:59], v4 offset:4608
    s_waitcnt lgkmcnt(6)
    v_mfma_f32_32x32x16_bf16 v[80:95], v[60:63], v[236:239], v[80:95]
    ds_read_b64_tr_b16 v[60:61], v4 offset:6144
    ds_read_b64_tr_b16 v[62:63], v4 offset:6656
    s_waitcnt lgkmcnt(6)
    v_mfma_f32_32x32x16_bf16 v[96:111], v[48:51], v[128:131], 0
    ds_read_b64_tr_b16 v[48:49], v4 offset:8192
    ds_read_b64_tr_b16 v[50:51], v4 offset:8704
    s_waitcnt lgkmcnt(6)
    v_mfma_f32_32x32x16_bf16 v[96:111], v[52:55], v[132:135], v[96:111]
    ds_read_b64_tr_b16 v[52:53], v4 offset:10240
    ds_read_b64_tr_b16 v[54:55], v4 offset:10752
    s_waitcnt lgkmcnt(6)
    v_mfma_f32_32x32x16_bf16 v[96:111], v[56:59], v[136:139], v[96:111]
    v_mul_f32 v16, v64, v64
    v_mul_f32 v17, v65, v65
    v_mul_f32 v18, v66, v66
    s_waitcnt vmcnt(11)
    s_barrier
    ds_read_b64_tr_b16 v[56:57], v4 offset:12288
    ds_read_b64_tr_b16 v[58:59], v4 offset:12800
    s_waitcnt lgkmcnt(6)
    v_mfma_f32_32x32x16_bf16 v[96:111], v[60:63], v[140:143], v[96:111]
    v_mul_f32 v19, v67, v67
    v_mul_f32 v20, v68, v68
    v_mul_f32 v21, v69, v69
    v_mul_f32 v22, v70, v70
    v_add_u32 v4, 57344, v11
    ds_read_b64_tr_b16 v[60:61], v4 offset:0
    ds_read_b64_tr_b16 v[62:63], v4 offset:512
    s_waitcnt lgkmcnt(6)
    v_mfma_f32_32x32x16_bf16 v[96:111], v[48:51], v[144:147], v[96:111]
    v_mul_f32 v23, v71, v71
    v_fma_f32 v16, v16, v10, v8
    v_fma_f32 v17, v17, v10, v8
    v_fma_f32 v18, v18, v10, v8
    ds_read_b64_tr_b16 v[48:49], v4 offset:2048
    ds_read_b64_tr_b16 v[50:51], v4 offset:2560
    s_waitcnt lgkmcnt(6)
    v_mfma_f32_32x32x16_bf16 v[96:111], v[52:55], v[148:151], v[96:111]
    v_fma_f32 v19, v19, v10, v8
    v_fma_f32 v20, v20, v10, v8
    v_fma_f32 v21, v21, v10, v8
    v_fma_f32 v22, v22, v10, v8
    ds_read_b64_tr_b16 v[52:53], v4 offset:4096
    ds_read_b64_tr_b16 v[54:55], v4 offset:4608
    s_waitcnt lgkmcnt(6)
    v_mfma_f32_32x32x16_bf16 v[96:111], v[56:59], v[152:155], v[96:111]
    v_fma_f32 v23, v23, v10, v8
    v_mul_f32 v16, v16, v64
    v_mul_f32 v17, v17, v65
    v_mul_f32 v18, v18, v66
    ds_read_b64_tr_b16 v[56:57], v4 offset:6144
    ds_read_b64_tr_b16 v[58:59], v4 offset:6656
    s_waitcnt lgkmcnt(6)
    v_mfma_f32_32x32x16_bf16 v[96:111], v[60:63], v[156:159], v[96:111]
    v_mul_f32 v19, v19, v67
    v_mul_f32 v20, v20, v68
    v_mul_f32 v21, v21, v69
    v_mul_f32 v22, v22, v70
    ds_read_b64_tr_b16 v[60:61], v4 offset:8192
    ds_read_b64_tr_b16 v[62:63], v4 offset:8704
    s_waitcnt lgkmcnt(6)
    v_mfma_f32_32x32x16_bf16 v[96:111], v[48:51], v[160:163], v[96:111]
    v_mul_f32 v23, v23, v71
    v_exp_f32 v16, v16
    v_mul_f32 v64, v64, v72
    v_exp_f32 v17, v17
    ds_read_b64_tr_b16 v[48:49], v4 offset:10240
    ds_read_b64_tr_b16 v[50:51], v4 offset:10752
    s_waitcnt lgkmcnt(6)
    v_mfma_f32_32x32x16_bf16 v[96:111], v[52:55], v[164:167], v[96:111]
    v_mul_f32 v65, v65, v73
    v_exp_f32 v18, v18
    v_mul_f32 v66, v66, v74
    v_exp_f32 v19, v19
    s_waitcnt vmcnt(5)
    s_barrier
    ds_read_b64_tr_b16 v[52:53], v4 offset:12288
    ds_read_b64_tr_b16 v[54:55], v4 offset:12800
    s_waitcnt lgkmcnt(6)
    v_mfma_f32_32x32x16_bf16 v[96:111], v[56:59], v[168:171], v[96:111]
    v_mul_f32 v67, v67, v75
    v_exp_f32 v20, v20
    v_mul_f32 v68, v68, v76
    v_exp_f32 v21, v21
    v_add_u32 v4, 86016, v11
    ds_read_b64_tr_b16 v[56:57], v4 offset:0
    ds_read_b64_tr_b16 v[58:59], v4 offset:512
    s_waitcnt lgkmcnt(6)
    v_mfma_f32_32x32x16_bf16 v[96:111], v[60:63], v[172:175], v[96:111]
    v_mul_f32 v69, v69, v77
    v_exp_f32 v22, v22
    v_mul_f32 v70, v70, v78
    v_exp_f32 v23, v23
    ds_read_b64_tr_b16 v[60:61], v4 offset:2048
    ds_read_b64_tr_b16 v[62:63], v4 offset:2560
    s_waitcnt lgkmcnt(6)
    v_mfma_f32_32x32x16_bf16 v[96:111], v[48:51], v[176:179], v[96:111]
    v_mul_f32 v71, v71, v79
    v_add_f32 v16, 1.0, v16
    v_add_f32 v17, 1.0, v17
    v_add_f32 v18, 1.0, v18
    ds_read_b64_tr_b16 v[48:49], v4 offset:4096
    ds_read_b64_tr_b16 v[50:51], v4 offset:4608
    s_waitcnt lgkmcnt(6)
    v_mfma_f32_32x32x16_bf16 v[96:111], v[52:55], v[180:183], v[96:111]
    v_add_f32 v19, 1.0, v19
    v_add_f32 v20, 1.0, v20
    v_add_f32 v21, 1.0, v21
    v_add_f32 v22, 1.0, v22
    ds_read_b64_tr_b16 v[52:53], v4 offset:6144
    ds_read_b64_tr_b16 v[54:55], v4 offset:6656
    s_waitcnt lgkmcnt(6)
    v_mfma_f32_32x32x16_bf16 v[96:111], v[56:59], v[184:187], v[96:111]
    v_add_f32 v23, 1.0, v23
    v_rcp_f32 v16, v16
    v_rcp_f32 v17, v17
    v_rcp_f32 v18, v18
    ds_read_b64_tr_b16 v[56:57], v4 offset:8192
    ds_read_b64_tr_b16 v[58:59], v4 offset:8704
    s_waitcnt lgkmcnt(6)
    v_mfma_f32_32x32x16_bf16 v[96:111], v[60:63], v[188:191], v[96:111]
    v_rcp_f32 v19, v19
    v_rcp_f32 v20, v20
    v_rcp_f32 v21, v21
    v_rcp_f32 v22, v22
    ds_read_b64_tr_b16 v[60:61], v4 offset:10240
    ds_read_b64_tr_b16 v[62:63], v4 offset:10752
    s_waitcnt lgkmcnt(6)
    v_mfma_f32_32x32x16_bf16 v[96:111], v[48:51], v[192:195], v[96:111]
    v_rcp_f32 v23, v23
    v_mul_f32 v64, v64, v16
    v_mul_f32 v65, v65, v17
    v_mul_f32 v66, v66, v18
    s_waitcnt vmcnt(0)
    s_barrier
    ds_read_b64_tr_b16 v[48:49], v4 offset:12288
    ds_read_b64_tr_b16 v[50:51], v4 offset:12800
    s_waitcnt lgkmcnt(6)
    v_mfma_f32_32x32x16_bf16 v[96:111], v[52:55], v[196:199], v[96:111]
    v_mul_f32 v67, v67, v19
    v_mul_f32 v68, v68, v20
    v_mul_f32 v69, v69, v21
    v_mul_f32 v70, v70, v22
    v_add_u32 v4, 114688, v11
    ds_read_b64_tr_b16 v[52:53], v4 offset:0
    ds_read_b64_tr_b16 v[54:55], v4 offset:512
    s_waitcnt lgkmcnt(6)
    v_mfma_f32_32x32x16_bf16 v[96:111], v[56:59], v[200:203], v[96:111]
    v_mul_f32 v71, v71, v23
    v_cvt_pk_bf16_f32 v24, v64, v65
    v_cvt_pk_bf16_f32 v25, v66, v67
    v_cvt_pk_bf16_f32 v26, v68, v69
    ds_read_b64_tr_b16 v[56:57], v4 offset:2048
    ds_read_b64_tr_b16 v[58:59], v4 offset:2560
    s_waitcnt lgkmcnt(6)
    v_mfma_f32_32x32x16_bf16 v[96:111], v[60:63], v[204:207], v[96:111]
    v_cvt_pk_bf16_f32 v27, v70, v71
    buffer_store_dwordx4 v[24:27], v6, s[48:51], s77 offen offset:0 sc1
    v_mul_f32 v28, v80, v80
    v_mul_f32 v29, v81, v81
    v_and_b32 v246, 0x13, v1
    v_bfe_u32 v9, v1, 2, 1
    v_lshl_or_b32 v246, v9, 3, v246
    v_bfe_u32 v9, v1, 3, 1
    v_lshl_or_b32 v246, v9, 2, v246
    v_mul_u32_u24 v246, 896, v246
    v_lshrrev_b32 v9, 5, v1
    v_lshl_add_u32 v9, v9, 4, v246
    buffer_load_dwordx4 v[40:43], v9, s[36:39], s31 offen
    ds_read_b64_tr_b16 v[60:61], v4 offset:4096
    ds_read_b64_tr_b16 v[62:63], v4 offset:4608
    s_waitcnt lgkmcnt(6)
    v_mfma_f32_32x32x16_bf16 v[96:111], v[48:51], v[208:211], v[96:111]
    v_mul_f32 v30, v82, v82
    v_mul_f32 v31, v83, v83
    v_mul_f32 v32, v84, v84
    v_mul_f32 v33, v85, v85
    ds_read_b64_tr_b16 v[48:49], v4 offset:6144
    ds_read_b64_tr_b16 v[50:51], v4 offset:6656
    s_waitcnt lgkmcnt(6)
    v_mfma_f32_32x32x16_bf16 v[96:111], v[52:55], v[212:215], v[96:111]
    v_mul_f32 v34, v86, v86
    v_mul_f32 v35, v87, v87
    v_fma_f32 v28, v28, v10, v8
    v_fma_f32 v29, v29, v10, v8
    ds_read_b64_tr_b16 v[52:53], v4 offset:8192
    ds_read_b64_tr_b16 v[54:55], v4 offset:8704
    s_waitcnt lgkmcnt(6)
    v_mfma_f32_32x32x16_bf16 v[96:111], v[56:59], v[216:219], v[96:111]
    v_fma_f32 v30, v30, v10, v8
    v_fma_f32 v31, v31, v10, v8
    v_fma_f32 v32, v32, v10, v8
    v_fma_f32 v33, v33, v10, v8
    ds_read_b64_tr_b16 v[56:57], v4 offset:10240
    ds_read_b64_tr_b16 v[58:59], v4 offset:10752
    s_waitcnt lgkmcnt(6)
    v_mfma_f32_32x32x16_bf16 v[96:111], v[60:63], v[220:223], v[96:111]
    v_fma_f32 v34, v34, v10, v8
    v_fma_f32 v35, v35, v10, v8
    v_mul_f32 v28, v28, v80
    v_mul_f32 v29, v29, v81
    ds_read_b64_tr_b16 v[60:61], v4 offset:12288
    ds_read_b64_tr_b16 v[62:63], v4 offset:12800
    s_waitcnt lgkmcnt(6)
    v_mfma_f32_32x32x16_bf16 v[96:111], v[48:51], v[224:227], v[96:111]
    s_add_u32 m0, s30, 81920
    s_add_u32 s73, s95, 573440
    s_sub_u32 s0, s73, 1605632
    s_min_u32 s73, s73, s0
    buffer_load_dwordx4 v44, s[52:55], s73 offen lds
    v_mul_f32 v30, v30, v82
    v_mul_f32 v31, v31, v83
    v_mul_f32 v32, v32, v84
    v_mul_f32 v33, v33, v85
    v_add_u32 v5, 28672, v12
    ds_read_b64_tr_b16 v[48:49], v5 offset:0
    ds_read_b64_tr_b16 v[50:51], v5 offset:512
    s_waitcnt lgkmcnt(6)
    v_mfma_f32_32x32x16_bf16 v[96:111], v[52:55], v[228:231], v[96:111]
    s_add_u32 m0, s30, 82944
    s_add_u32 s73, s95, 580608
    s_sub_u32 s0, s73, 1605632
    s_min_u32 s73, s73, s0
    buffer_load_dwordx4 v44, s[52:55], s73 offen lds
    v_mul_f32 v34, v34, v86
    v_mul_f32 v35, v35, v87
    v_exp_f32 v28, v28
    v_mul_f32 v80, v80, v88
    buffer_load_dwordx2 v[254:255], v253, s[48:51], 0 offen sc1
    ds_read_b64_tr_b16 v[52:53], v5 offset:2048
    ds_read_b64_tr_b16 v[54:55], v5 offset:2560
    s_waitcnt lgkmcnt(6)
    v_mfma_f32_32x32x16_bf16 v[96:111], v[56:59], v[232:235], v[96:111]
    v_exp_f32 v29, v29
    v_mul_f32 v81, v81, v89
    v_exp_f32 v30, v30
    v_mul_f32 v82, v82, v90
    ds_read_b64_tr_b16 v[56:57], v5 offset:4096
    ds_read_b64_tr_b16 v[58:59], v5 offset:4608
    s_waitcnt lgkmcnt(6)
    v_mfma_f32_32x32x16_bf16 v[96:111], v[60:63], v[236:239], v[96:111]
    v_exp_f32 v31, v31
    v_mul_f32 v83, v83, v91
    v_exp_f32 v32, v32
    v_mul_f32 v84, v84, v92
    ds_read_b64_tr_b16 v[60:61], v5 offset:6144
    ds_read_b64_tr_b16 v[62:63], v5 offset:6656
    s_waitcnt lgkmcnt(6)
    v_mfma_f32_32x32x16_bf16 v[112:127], v[48:51], v[128:131], 0
    v_exp_f32 v33, v33
    v_mul_f32 v85, v85, v93
    v_exp_f32 v34, v34
    v_mul_f32 v86, v86, v94
    ds_read_b64_tr_b16 v[48:49], v5 offset:8192
    ds_read_b64_tr_b16 v[50:51], v5 offset:8704
    s_waitcnt lgkmcnt(6)
    v_mfma_f32_32x32x16_bf16 v[112:127], v[52:55], v[132:135], v[112:127]
    v_exp_f32 v35, v35
    v_mul_f32 v87, v87, v95
    v_add_f32 v28, 1.0, v28
    v_add_f32 v29, 1.0, v29
    ds_read_b64_tr_b16 v[52:53], v5 offset:10240
    ds_read_b64_tr_b16 v[54:55], v5 offset:10752
    s_waitcnt lgkmcnt(6)
    v_mfma_f32_32x32x16_bf16 v[112:127], v[56:59], v[136:139], v[112:127]
    v_add_f32 v30, 1.0, v30
    v_add_f32 v31, 1.0, v31
    v_add_f32 v32, 1.0, v32
    v_add_f32 v33, 1.0, v33
    ds_read_b64_tr_b16 v[56:57], v5 offset:12288
    ds_read_b64_tr_b16 v[58:59], v5 offset:12800
    s_waitcnt lgkmcnt(6)
    v_mfma_f32_32x32x16_bf16 v[112:127], v[60:63], v[140:143], v[112:127]
    v_add_f32 v34, 1.0, v34
    v_add_f32 v35, 1.0, v35
    v_rcp_f32 v28, v28
    v_rcp_f32 v29, v29
    v_add_u32 v5, 57344, v12
    ds_read_b64_tr_b16 v[60:61], v5 offset:0
    ds_read_b64_tr_b16 v[62:63], v5 offset:512
    s_waitcnt lgkmcnt(6)
    v_mfma_f32_32x32x16_bf16 v[112:127], v[48:51], v[144:147], v[112:127]
    v_rcp_f32 v30, v30
    v_rcp_f32 v31, v31
    v_rcp_f32 v32, v32
    v_rcp_f32 v33, v33
    ds_read_b64_tr_b16 v[48:49], v5 offset:2048
    ds_read_b64_tr_b16 v[50:51], v5 offset:2560
    s_waitcnt lgkmcnt(6)
    v_mfma_f32_32x32x16_bf16 v[112:127], v[52:55], v[148:151], v[112:127]
    v_rcp_f32 v34, v34
    v_rcp_f32 v35, v35
    v_mul_f32 v80, v80, v28
    v_mul_f32 v81, v81, v29
    ds_read_b64_tr_b16 v[52:53], v5 offset:4096
    ds_read_b64_tr_b16 v[54:55], v5 offset:4608
    s_waitcnt lgkmcnt(6)
    v_mfma_f32_32x32x16_bf16 v[112:127], v[56:59], v[152:155], v[112:127]
    v_mul_f32 v82, v82, v30
    v_mul_f32 v83, v83, v31
    v_mul_f32 v84, v84, v32
    v_mul_f32 v85, v85, v33
    ds_read_b64_tr_b16 v[56:57], v5 offset:6144
    ds_read_b64_tr_b16 v[58:59], v5 offset:6656
    s_waitcnt lgkmcnt(6)
    v_mfma_f32_32x32x16_bf16 v[112:127], v[60:63], v[156:159], v[112:127]
    v_mul_f32 v86, v86, v34
    v_mul_f32 v87, v87, v35
    v_cvt_pk_bf16_f32 v36, v80, v81
    v_cvt_pk_bf16_f32 v37, v82, v83
    ds_read_b64_tr_b16 v[60:61], v5 offset:8192
    ds_read_b64_tr_b16 v[62:63], v5 offset:8704
    s_waitcnt lgkmcnt(6)
    v_mfma_f32_32x32x16_bf16 v[112:127], v[48:51], v[160:163], v[112:127]
    v_cvt_pk_bf16_f32 v38, v84, v85
    v_cvt_pk_bf16_f32 v39, v86, v87
    buffer_store_dwordx4 v[36:39], v6, s[48:51], s77 offen offset:1024 sc1
    s_add_u32 s77, s77, 4096
    ds_read_b64_tr_b16 v[48:49], v5 offset:10240
    ds_read_b64_tr_b16 v[50:51], v5 offset:10752
    s_waitcnt lgkmcnt(6)
    v_mfma_f32_32x32x16_bf16 v[112:127], v[52:55], v[164:167], v[112:127]
    v_mul_f32 v16, v96, v96
    v_mul_f32 v17, v97, v97
    v_mul_f32 v18, v98, v98
    v_mul_f32 v19, v99, v99
    s_cmp_lg_u32 s68, 0
    s_nop 6
    s_cbranch_scc1 L_wf_done1
    s_mov_b32 s76, 0
    s_waitcnt vmcnt(1)
L_wf1:
    v_cmp_eq_u64 vcc, v[254:255], v[248:249]
    s_nop 0
    s_and_b32 s75, vcc_lo, 15
    s_cmp_eq_u32 s75, 15
    s_nop 1
    s_cbranch_scc1 L_wf_done1
    s_add_u32 s76, s76, 1
    s_cmp_gt_u32 s76, 100000
    s_cbranch_scc1 L_wf_done1
    s_sleep 4
    buffer_load_dwordx2 v[254:255], v253, s[48:51], 0 offen sc1
    s_waitcnt vmcnt(0)
    s_branch L_wf1
L_wf_done1:
    s_barrier
    ds_read_b64_tr_b16 v[52:53], v5 offset:12288
    ds_read_b64_tr_b16 v[54:55], v5 offset:12800
    s_waitcnt lgkmcnt(6)
    v_mfma_f32_32x32x16_bf16 v[112:127], v[56:59], v[168:171], v[112:127]
    s_mul_i32 s0, s68, 3072
    s_mov_b32 m0, s0
    s_add_u32 s73, s81, 2097152
    buffer_load_dwordx4 v6, s[48:51], s73 offen offset:0 sc1 lds
    s_add_u32 s73, s82, 2096128
    buffer_load_dwordx4 v6, s[48:51], s73 offen offset:1024 sc1 lds
    s_add_u32 s73, s83, 2095104
    buffer_load_dwordx4 v6, s[48:51], s73 offen offset:2048 sc1 lds
    v_mul_f32 v20, v100, v100
    v_mul_f32 v21, v101, v101
    v_mul_f32 v22, v102, v102
    v_mul_f32 v23, v103, v103
    v_add_u32 v5, 86016, v12
    ds_read_b64_tr_b16 v[56:57], v5 offset:0
    ds_read_b64_tr_b16 v[58:59], v5 offset:512
    s_waitcnt lgkmcnt(6)
    v_mfma_f32_32x32x16_bf16 v[112:127], v[60:63], v[172:175], v[112:127]
    s_lshr_b32 s0, s68, 1
    s_lshl_b32 s0, s0, 11
    s_add_u32 s0, s0, s85
    s_add_u32 s0, s0, s84
    buffer_load_dwordx4 v[240:243], v244, s[48:51], s0 offen sc1
    v_fma_f32 v16, v16, v10, v8
    v_fma_f32 v17, v17, v10, v8
    v_fma_f32 v18, v18, v10, v8
    v_fma_f32 v19, v19, v10, v8
    ds_read_b64_tr_b16 v[60:61], v5 offset:2048
    ds_read_b64_tr_b16 v[62:63], v5 offset:2560
    s_waitcnt lgkmcnt(6)
    v_mfma_f32_32x32x16_bf16 v[112:127], v[48:51], v[176:179], v[112:127]
    v_fma_f32 v20, v20, v10, v8
    v_fma_f32 v21, v21, v10, v8
    v_fma_f32 v22, v22, v10, v8
    v_fma_f32 v23, v23, v10, v8
    ds_read_b64_tr_b16 v[48:49], v5 offset:4096
    ds_read_b64_tr_b16 v[50:51], v5 offset:4608
    s_waitcnt lgkmcnt(6)
    v_mfma_f32_32x32x16_bf16 v[112:127], v[52:55], v[180:183], v[112:127]
    v_mul_f32 v16, v16, v96
    v_mul_f32 v17, v17, v97
    v_mul_f32 v18, v18, v98
    v_mul_f32 v19, v19, v99
    ds_read_b64_tr_b16 v[52:53], v5 offset:6144
    ds_read_b64_tr_b16 v[54:55], v5 offset:6656
    s_waitcnt lgkmcnt(6)
    v_mfma_f32_32x32x16_bf16 v[112:127], v[56:59], v[184:187], v[112:127]
    v_mul_f32 v20, v20, v100
    v_mul_f32 v21, v21, v101
    v_mul_f32 v22, v22, v102
    v_mul_f32 v23, v23, v103
    v_exp_f32 v16, v16
    ds_read_b64_tr_b16 v[56:57], v5 offset:8192
    ds_read_b64_tr_b16 v[58:59], v5 offset:8704
    s_waitcnt lgkmcnt(6)
    v_mfma_f32_32x32x16_bf16 v[112:127], v[60:63], v[188:191], v[112:127]
    v_mul_f32 v96, v96, v104
    v_exp_f32 v17, v17
    v_mul_f32 v97, v97, v105
    v_exp_f32 v18, v18
    buffer_load_dwordx2 v[254:255], v47, s[48:51], 0 offen sc1
    ds_read_b64_tr_b16 v[60:61], v5 offset:10240
    ds_read_b64_tr_b16 v[62:63], v5 offset:10752
    s_waitcnt lgkmcnt(6)
    v_mfma_f32_32x32x16_bf16 v[112:127], v[48:51], v[192:195], v[112:127]
    v_mul_f32 v98, v98, v106
    v_exp_f32 v19, v19
    v_mul_f32 v99, v99, v107
    v_exp_f32 v20, v20
    ds_read_b64_tr_b16 v[48:49], v5 offset:12288
    ds_read_b64_tr_b16 v[50:51], v5 offset:12800
    s_waitcnt lgkmcnt(6)
    v_mfma_f32_32x32x16_bf16 v[112:127], v[52:55], v[196:199], v[112:127]
    v_mul_f32 v100, v100, v108
    v_exp_f32 v21, v21
    v_mul_f32 v101, v101, v109
    v_exp_f32 v22, v22
    v_add_u32 v5, 114688, v12
    ds_read_b64_tr_b16 v[52:53], v5 offset:0
    ds_read_b64_tr_b16 v[54:55], v5 offset:512
    s_waitcnt lgkmcnt(6)
    v_mfma_f32_32x32x16_bf16 v[112:127], v[56:59], v[200:203], v[112:127]
    v_mul_f32 v102, v102, v110
    v_exp_f32 v23, v23
    v_mul_f32 v103, v103, v111
    v_add_f32 v16, 1.0, v16
    ds_read_b64_tr_b16 v[56:57], v5 offset:2048
    ds_read_b64_tr_b16 v[58:59], v5 offset:2560
    s_waitcnt lgkmcnt(6)
    v_mfma_f32_32x32x16_bf16 v[112:127], v[60:63], v[204:207], v[112:127]
    v_add_f32 v17, 1.0, v17
    v_add_f32 v18, 1.0, v18
    v_add_f32 v19, 1.0, v19
    v_add_f32 v20, 1.0, v20
    ds_read_b64_tr_b16 v[60:61], v5 offset:4096
    ds_read_b64_tr_b16 v[62:63], v5 offset:4608
    s_waitcnt lgkmcnt(6)
    v_mfma_f32_32x32x16_bf16 v[112:127], v[48:51], v[208:211], v[112:127]
    v_add_f32 v21, 1.0, v21
    v_add_f32 v22, 1.0, v22
    v_add_f32 v23, 1.0, v23
    v_rcp_f32 v16, v16
    ds_read_b64_tr_b16 v[48:49], v5 offset:6144
    ds_read_b64_tr_b16 v[50:51], v5 offset:6656
    s_waitcnt lgkmcnt(6)
    v_mfma_f32_32x32x16_bf16 v[112:127], v[52:55], v[212:215], v[112:127]
    v_rcp_f32 v17, v17
    v_rcp_f32 v18, v18
    v_rcp_f32 v19, v19
    v_rcp_f32 v20, v20
    ds_read_b64_tr_b16 v[52:53], v5 offset:8192
    ds_read_b64_tr_b16 v[54:55], v5 offset:8704
    s_waitcnt lgkmcnt(6)
    v_mfma_f32_32x32x16_bf16 v[112:127], v[56:59], v[216:219], v[112:127]
    v_rcp_f32 v21, v21
    v_rcp_f32 v22, v22
    v_rcp_f32 v23, v23
    v_mul_f32 v96, v96, v16
    ds_read_b64_tr_b16 v[56:57], v5 offset:10240
    ds_read_b64_tr_b16 v[58:59], v5 offset:10752
    s_waitcnt lgkmcnt(6)
    v_mfma_f32_32x32x16_bf16 v[112:127], v[60:63], v[220:223], v[112:127]
    v_mul_f32 v97, v97, v17
    v_mul_f32 v98, v98, v18
    v_mul_f32 v99, v99, v19
    v_mul_f32 v100, v100, v20
    ds_read_b64_tr_b16 v[60:61], v5 offset:12288
    ds_read_b64_tr_b16 v[62:63], v5 offset:12800
    s_waitcnt lgkmcnt(6)
    v_mfma_f32_32x32x16_bf16 v[112:127], v[48:51], v[224:227], v[112:127]
    v_mul_f32 v101, v101, v21
    v_mul_f32 v102, v102, v22
    v_mul_f32 v103, v103, v23
    v_cvt_pk_bf16_f32 v24, v96, v97
    s_waitcnt lgkmcnt(4)
    v_mfma_f32_32x32x16_bf16 v[112:127], v[52:55], v[228:231], v[112:127]
    v_cvt_pk_bf16_f32 v25, v98, v99
    v_cvt_pk_bf16_f32 v26, v100, v101
    v_cvt_pk_bf16_f32 v27, v102, v103
    buffer_store_dwordx4 v[24:27], v6, s[48:51], s77 offen offset:0 sc1
    s_waitcnt lgkmcnt(2)
    v_mfma_f32_32x32x16_bf16 v[112:127], v[56:59], v[232:235], v[112:127]
    s_waitcnt lgkmcnt(0)
    v_mfma_f32_32x32x16_bf16 v[112:127], v[60:63], v[236:239], v[112:127]
    s_cmp_lg_u32 s68, 0
    s_nop 10
    s_cbranch_scc1 L_wf_done2
    s_mov_b32 s76, 0
    s_waitcnt vmcnt(1)
L_wf2:
    v_cmp_eq_u64 vcc, v[254:255], v[248:249]
    s_nop 0
    s_and_b32 s75, vcc_lo, 7
    s_cmp_eq_u32 s75, 7
    s_nop 1
    s_cbranch_scc1 L_wf_done2
    s_add_u32 s76, s76, 1
    s_cmp_gt_u32 s76, 100000
    s_cbranch_scc1 L_wf_done2
    s_sleep 4
    buffer_load_dwordx2 v[254:255], v47, s[48:51], 0 offen sc1
    s_waitcnt vmcnt(0)
    s_branch L_wf2
L_wf_done2:
    s_waitcnt vmcnt(2)
    s_branch L_postA
L_type2:
    ds_read_b128 v[128:131], v32 offset:0
    v_add_u32 v4, 0, v9
    ds_read_b64_tr_b16 v[48:49], v4 offset:0
    ds_read_b64_tr_b16 v[50:51], v4 offset:512
    ds_read_b128 v[132:135], v33 offset:0
    ds_read_b64_tr_b16 v[52:53], v4 offset:2048
    ds_read_b64_tr_b16 v[54:55], v4 offset:2560
    ds_read_b128 v[136:139], v34 offset:0
    ds_read_b64_tr_b16 v[56:57], v4 offset:4096
    ds_read_b64_tr_b16 v[58:59], v4 offset:4608
    ds_read_b128 v[140:143], v35 offset:0
    ds_read_b128 v[144:147], v32 offset:16384
    ds_read_b128 v[148:151], v33 offset:16384
    ds_read_b64_tr_b16 v[60:61], v4 offset:6144
    ds_read_b64_tr_b16 v[62:63], v4 offset:6656
    ds_read_b128 v[152:155], v34 offset:16384
    ds_read_b128 v[156:159], v35 offset:16384
    ds_read_b128 v[160:163], v32 offset:32768
    s_waitcnt lgkmcnt(14)
    v_mfma_f32_32x32x16_bf16 v[96:111], v[48:51], v[128:131], 0
    v_lshrrev_b32 v16, 4, v1
    v_and_b32 v17, 15, v1
    v_mul_u32_u24 v18, 2688, v16
    ds_read_b64_tr_b16 v[48:49], v4 offset:8192
    ds_read_b64_tr_b16 v[50:51], v4 offset:8704
    ds_read_b128 v[164:167], v33 offset:32768
    ds_read_b128 v[168:171], v34 offset:32768
    ds_read_b128 v[172:175], v35 offset:32768
    s_waitcnt lgkmcnt(15)
    v_mfma_f32_32x32x16_bf16 v[96:111], v[52:55], v[132:135], v[96:111]
    v_lshlrev_b32 v19, 2, v16
    v_xor_b32 v19, v19, v17
    v_lshl_add_u32 v40, v19, 4, v18
    ds_read_b64_tr_b16 v[52:53], v4 offset:10240
    ds_read_b64_tr_b16 v[54:55], v4 offset:10752
    ds_read_b128 v[176:179], v32 offset:49152
    ds_read_b128 v[180:183], v33 offset:49152
    ds_read_b128 v[184:187], v34 offset:49152
    s_waitcnt lgkmcnt(15)
    v_mfma_f32_32x32x16_bf16 v[96:111], v[56:59], v[136:139], v[96:111]
    s_and_b32 s96, s68, 1
    s_lshl_b32 s96, s96, 7
    v_lshlrev_b32 v19, 4, v19
    v_xor_b32 v19, s96, v19
    ds_read_b64_tr_b16 v[56:57], v4 offset:12288
    ds_read_b64_tr_b16 v[58:59], v4 offset:12800
    ds_read_b128 v[188:191], v35 offset:49152
    ds_read_b128 v[192:195], v36 offset:0
    ds_read_b128 v[196:199], v37 offset:0
    s_waitcnt lgkmcnt(15)
    v_mfma_f32_32x32x16_bf16 v[96:111], v[60:63], v[140:143], v[96:111]
    v_add_u32 v41, v19, v18
    v_bfe_u32 v16, v1, 2, 2
    v_and_b32 v17, 3, v1
    s_waitcnt lgkmcnt(10)
    s_barrier
    s_add_u32 m0, s22, 49152
    s_add_u32 s73, s4, 1032192
    buffer_load_dwordx4 v2, s[40:43], s73 offen lds
    ds_read_b64_tr_b16 v[60:61], v4 offset:14336
    ds_read_b64_tr_b16 v[62:63], v4 offset:14848
    ds_read_b128 v[200:203], v38 offset:0
    ds_read_b128 v[204:207], v39 offset:0
    ds_read_b128 v[208:211], v36 offset:16384
    s_waitcnt lgkmcnt(15)
    v_mfma_f32_32x32x16_bf16 v[96:111], v[48:51], v[144:147], v[96:111]
    s_add_u32 m0, s22, 57344
    s_add_u32 s73, s6, 0
    buffer_load_dwordx4 v40, s[40:43], s73 offen lds
    v_bfe_u32 v18, v1, 4, 1
    v_lshrrev_b32 v19, 5, v1
    v_lshl_add_u32 v19, v19, 3, v16
    ds_read_b64_tr_b16 v[48:49], v4 offset:16384
    ds_read_b64_tr_b16 v[50:51], v4 offset:16896
    ds_read_b128 v[212:215], v37 offset:16384
    ds_read_b128 v[216:219], v38 offset:16384
    ds_read_b128 v[220:223], v39 offset:16384
    s_waitcnt lgkmcnt(15)
    v_mfma_f32_32x32x16_bf16 v[96:111], v[52:55], v[148:151], v[96:111]
    s_add_u32 m0, s22, 65536
    s_add_u32 s73, s6, 86016
    buffer_load_dwordx4 v40, s[40:43], s73 offen lds
    v_lshlrev_b32 v19, 8, v19
    v_lshlrev_b32 v17, 4, v17
    v_lshl_add_u32 v17, v18, 3, v17
    s_mul_i32 s96, s71, 112
    ds_read_b64_tr_b16 v[52:53], v4 offset:18432
    ds_read_b64_tr_b16 v[54:55], v4 offset:18944
    ds_read_b128 v[224:227], v36 offset:32768
    ds_read_b128 v[228:231], v37 offset:32768
    ds_read_b128 v[232:235], v38 offset:32768
    s_waitcnt lgkmcnt(15)
    v_mfma_f32_32x32x16_bf16 v[96:111], v[56:59], v[152:155], v[96:111]
    s_add_u32 m0, s22, 73728
    s_add_u32 s73, s6, 172032
    buffer_load_dwordx4 v40, s[40:43], s73 offen lds
    v_add_u32 v17, s96, v17
    v_lshlrev_b32 v16, 6, v16
    v_xor_b32 v18, v17, v16
    ds_read_b64_tr_b16 v[56:57], v4 offset:20480
    ds_read_b64_tr_b16 v[58:59], v4 offset:20992
    ds_read_b128 v[236:239], v39 offset:32768
    s_waitcnt lgkmcnt(15)
    v_mfma_f32_32x32x16_bf16 v[96:111], v[60:63], v[156:159], v[96:111]
    s_add_u32 m0, s23, 65536
    s_add_u32 s73, s7, 0
    s_mov_b32 exec_hi, 0
    buffer_load_dwordx4 v41, s[40:43], s73 offen lds
    s_mov_b32 exec_hi, -1
    v_add_u32 v42, v18, v19
    v_add_u32 v17, 56, v17
    v_xor_b32 v18, v17, v16
    ds_read_b64_tr_b16 v[60:61], v4 offset:22528
    ds_read_b64_tr_b16 v[62:63], v4 offset:23040
    s_waitcnt lgkmcnt(13)
    v_mfma_f32_32x32x16_bf16 v[96:111], v[48:51], v[160:163], v[96:111]
    v_add_u32 v43, v18, v19
    s_and_b32 s96, s2, 7
    s_lshr_b32 s97, s2, 7
    s_lshl1_add_u32 s18, s96, s97
    ds_read_b64_tr_b16 v[48:49], v4 offset:24576
    ds_read_b64_tr_b16 v[50:51], v4 offset:25088
    s_waitcnt lgkmcnt(10)
    v_mfma_f32_32x32x16_bf16 v[96:111], v[52:55], v[164:167], v[96:111]
    s_bfe_u32 s19, s2, 0x40003
    s_bfe_u32 s97, s2, 0x20003
    s_lshl2_add_u32 s88, s96, s97
    s_waitcnt vmcnt(7) lgkmcnt(4)
    s_barrier
    ds_read_b64_tr_b16 v[52:53], v4 offset:26624
    ds_read_b64_tr_b16 v[54:55], v4 offset:27136
    s_waitcnt lgkmcnt(7)
    v_mfma_f32_32x32x16_bf16 v[96:111], v[56:59], v[168:171], v[96:111]
    s_add_u32 m0, s22, 86016
    s_add_u32 s73, s6, 301056
    buffer_load_dwordx4 v40, s[40:43], s73 offen lds
    s_lshr_b32 s89, s2, 5
    s_lshr_b32 s96, s18, 1
    s_or_b32 s97, s18, 3
    v_add_u32 v4, 28672, v9
    ds_read_b64_tr_b16 v[56:57], v4 offset:0
    ds_read_b64_tr_b16 v[58:59], v4 offset:512
    s_waitcnt lgkmcnt(6)
    v_mfma_f32_32x32x16_bf16 v[96:111], v[60:63], v[172:175], v[96:111]
    s_add_u32 m0, s22, 94208
    s_add_u32 s73, s6, 387072
    buffer_load_dwordx4 v40, s[40:43], s73 offen lds
    v_min_u32 v24, 1, v1
    v_sub_u32 v25, v1, v24
    v_sub_u32 v25, s19, v25
    v_max_i32 v25, 0, v25
    ds_read_b64_tr_b16 v[60:61], v4 offset:2048
    ds_read_b64_tr_b16 v[62:63], v4 offset:2560
    s_waitcnt lgkmcnt(6)
    v_mfma_f32_32x32x16_bf16 v[96:111], v[48:51], v[176:179], v[96:111]
    s_add_u32 m0, s22, 102400
    s_add_u32 s73, s6, 473088
    buffer_load_dwordx4 v40, s[40:43], s73 offen lds
    v_lshl_add_u32 v24, v24, 3, s96
    v_lshl_add_u32 v24, v25, 4, v24
    v_lshlrev_b32 v24, 3, v24
    ds_read_b64_tr_b16 v[48:49], v4 offset:4096
    ds_read_b64_tr_b16 v[50:51], v4 offset:4608
    s_waitcnt lgkmcnt(6)
    v_mfma_f32_32x32x16_bf16 v[96:111], v[52:55], v[180:183], v[96:111]
    s_add_u32 m0, s23, 94208
    s_add_u32 s73, s7, 301056
    s_mov_b32 exec_hi, 0
    buffer_load_dwordx4 v41, s[40:43], s73 offen lds
    s_mov_b32 exec_hi, -1
    v_add_u32 v24, 6291456, v24
    v_sub_u32 v25, s19, v1
    v_max_i32 v25, 0, v25
    ds_read_b64_tr_b16 v[52:53], v4 offset:6144
    ds_read_b64_tr_b16 v[54:55], v4 offset:6656
    s_waitcnt lgkmcnt(6)
    v_mfma_f32_32x32x16_bf16 v[96:111], v[56:59], v[184:187], v[96:111]
    s_add_u32 m0, s22, 114688
    s_add_u32 s73, s6, 602112
    buffer_load_dwordx4 v40, s[40:43], s73 offen lds
    v_lshl_add_u32 v25, v25, 4, s97
    v_lshlrev_b32 v25, 3, v25
    v_add_u32 v25, 6297600, v25
    v_mov_b32 v26, 2147483392
    ds_read_b64_tr_b16 v[56:57], v4 offset:8192
    ds_read_b64_tr_b16 v[58:59], v4 offset:8704
    s_waitcnt lgkmcnt(6)
    v_mfma_f32_32x32x16_bf16 v[96:111], v[60:63], v[188:191], v[96:111]
    s_add_u32 m0, s22, 122880
    s_add_u32 s73, s6, 688128
    buffer_load_dwordx4 v40, s[40:43], s73 offen lds
    v_cmp_gt_u32 s[96:97], 4, v0
    s_nop 1
    v_cndmask_b32 v253, v26, v24, s[96:97]
    v_cndmask_b32 v47, v26, v25, s[96:97]
    ds_read_b64_tr_b16 v[60:61], v4 offset:10240
    ds_read_b64_tr_b16 v[62:63], v4 offset:10752
    s_waitcnt lgkmcnt(6)
    v_mfma_f32_32x32x16_bf16 v[96:111], v[48:51], v[192:195], v[96:111]
    s_add_u32 m0, s22, 131072
    s_add_u32 s73, s6, 774144
    buffer_load_dwordx4 v40, s[40:43], s73 offen lds
    s_lshr_b32 s96, s88, 1
    s_lshl_b32 s96, s96, 7
    s_add_u32 s96, s96, 6293504
    ds_read_b64_tr_b16 v[48:49], v4 offset:12288
    ds_read_b64_tr_b16 v[50:51], v4 offset:12800
    s_waitcnt lgkmcnt(6)
    v_mfma_f32_32x32x16_bf16 v[96:111], v[52:55], v[196:199], v[96:111]
    s_add_u32 m0, s23, 122880
    s_add_u32 s73, s7, 602112
    s_mov_b32 exec_hi, 0
    buffer_load_dwordx4 v41, s[40:43], s73 offen lds
    s_mov_b32 exec_hi, -1
    v_lshl_add_u32 v24, v1, 3, s96
    v_cmp_gt_u32 s[96:97], 16, v0
    s_nop 1
    v_cndmask_b32 v46, v26, v24, s[96:97]
    s_lshl4_add_u32 s20, s69, s70
    ds_read_b64_tr_b16 v[52:53], v4 offset:14336
    ds_read_b64_tr_b16 v[54:55], v4 offset:14848
    s_waitcnt lgkmcnt(6)
    v_mfma_f32_32x32x16_bf16 v[96:111], v[56:59], v[200:203], v[96:111]
    buffer_load_dwordx2 v[248:249], v251, s[64:67], 0 offen sc1
    s_lshl_b32 s20, s20, 3
    s_add_u32 s20, s20, 6291456
    s_lshl4_add_u32 s80, s19, s18
    ds_read_b64_tr_b16 v[56:57], v4 offset:16384
    ds_read_b64_tr_b16 v[58:59], v4 offset:16896
    s_waitcnt lgkmcnt(6)
    v_mfma_f32_32x32x16_bf16 v[96:111], v[60:63], v[204:207], v[96:111]
    s_lshl_b32 s80, s80, 3
    s_add_u32 s80, s80, 6291456
    s_lshl_b32 s84, s18, 17
    s_waitcnt vmcnt(13)
    s_barrier
    ds_read_b64_tr_b16 v[60:61], v4 offset:18432
    ds_read_b64_tr_b16 v[62:63], v4 offset:18944
    s_waitcnt lgkmcnt(6)
    v_mfma_f32_32x32x16_bf16 v[96:111], v[48:51], v[208:211], v[96:111]
    s_lshl_b32 s96, s19, 13
    s_mul_i32 s97, s68, 3072
    s_add_u32 s97, s97, s96
    s_sub_u32 s81, s97, 16384
    ds_read_b64_tr_b16 v[48:49], v4 offset:20480
    ds_read_b64_tr_b16 v[50:51], v4 offset:20992
    s_waitcnt lgkmcnt(6)
    v_mfma_f32_32x32x16_bf16 v[96:111], v[52:55], v[212:215], v[96:111]
    s_max_i32 s81, s81, 0
    s_add_u32 s81, s81, s84
    s_sub_u32 s82, s97, 15360
    ds_read_b64_tr_b16 v[52:53], v4 offset:22528
    ds_read_b64_tr_b16 v[54:55], v4 offset:23040
    s_waitcnt lgkmcnt(6)
    v_mfma_f32_32x32x16_bf16 v[96:111], v[56:59], v[216:219], v[96:111]
    s_max_i32 s82, s82, 0
    s_add_u32 s82, s82, s84
    s_sub_u32 s83, s97, 14336
    ds_read_b64_tr_b16 v[56:57], v4 offset:24576
    ds_read_b64_tr_b16 v[58:59], v4 offset:25088
    s_waitcnt lgkmcnt(6)
    v_mfma_f32_32x32x16_bf16 v[96:111], v[60:63], v[220:223], v[96:111]
    s_max_i32 s83, s83, 0
    s_add_u32 s83, s83, s84
    s_add_u32 s84, s84, s96
    v_and_b32 v24, 15, v1
    s_waitcnt vmcnt(9)
    s_barrier
    ds_read_b64_tr_b16 v[60:61], v4 offset:26624
    ds_read_b64_tr_b16 v[62:63], v4 offset:27136
    s_waitcnt lgkmcnt(6)
    v_mfma_f32_32x32x16_bf16 v[96:111], v[48:51], v[224:227], v[96:111]
    s_add_u32 m0, s22, 0
    s_add_u32 s73, s6, 903168
    buffer_load_dwordx4 v40, s[40:43], s73 offen lds
    v_lshrrev_b32 v25, 4, v1
    v_lshlrev_b32 v244, 9, v25
    v_lshl_add_u32 v244, v24, 4, v244
    v_add_u32 v4, 57344, v42
    v_add_u32 v5, 57344, v43
    ds_read_b64_tr_b16 v[48:49], v4 offset:0
    ds_read_b64_tr_b16 v[50:51], v4 offset:1024
    s_waitcnt lgkmcnt(6)
    v_mfma_f32_32x32x16_bf16 v[96:111], v[52:55], v[228:231], v[96:111]
    s_add_u32 m0, s22, 8192
    s_add_u32 s73, s6, 989184
    buffer_load_dwordx4 v40, s[40:43], s73 offen lds
    s_and_b32 s92, s68, 1
    s_lshl_b32 s85, s92, 8
    s_lshr_b32 s86, s68, 1
    ds_read_b64_tr_b16 v[52:53], v5 offset:0
    ds_read_b64_tr_b16 v[54:55], v5 offset:1024
    s_waitcnt lgkmcnt(6)
    v_mfma_f32_32x32x16_bf16 v[96:111], v[56:59], v[232:235], v[96:111]
    s_add_u32 m0, s22, 16384
    s_add_u32 s73, s6, 1075200
    buffer_load_dwordx4 v40, s[40:43], s73 offen lds
    s_lshl2_add_u32 s86, s19, s86
    ds_read_b64_tr_b16 v[56:57], v4 offset:4096
    ds_read_b64_tr_b16 v[58:59], v4 offset:5120
    s_waitcnt lgkmcnt(6)
    v_mfma_f32_32x32x16_bf16 v[96:111], v[60:63], v[236:239], v[96:111]
    s_add_u32 m0, s23, 8192
    s_add_u32 s73, s7, 903168
    s_mov_b32 exec_hi, 0
    buffer_load_dwordx4 v41, s[40:43], s73 offen lds
    s_mov_b32 exec_hi, -1
    ds_read_b64_tr_b16 v[60:61], v5 offset:4096
    ds_read_b64_tr_b16 v[62:63], v5 offset:5120
    s_waitcnt lgkmcnt(6)
    v_mfma_f32_32x32x16_bf16 v[64:79], v[128:131], v[48:51], 0
    ds_read_b64_tr_b16 v[48:49], v4 offset:8192
    ds_read_b64_tr_b16 v[50:51], v4 offset:9216
    s_waitcnt lgkmcnt(6)
    v_mfma_f32_32x32x16_bf16 v[80:95], v[128:131], v[52:55], 0
    ds_read_b64_tr_b16 v[52:53], v5 offset:8192
    ds_read_b64_tr_b16 v[54:55], v5 offset:9216
    s_waitcnt lgkmcnt(6)
    v_mfma_f32_32x32x16_bf16 v[64:79], v[132:135], v[56:59], v[64:79]
    v_mul_f32 v96, s12, v96
    v_mul_f32 v97, s12, v97
    ds_read_b64_tr_b16 v[56:57], v4 offset:12288
    ds_read_b64_tr_b16 v[58:59], v4 offset:13312
    s_waitcnt lgkmcnt(6)
    v_mfma_f32_32x32x16_bf16 v[80:95], v[132:135], v[60:63], v[80:95]
    v_mul_f32 v98, s12, v98
    v_mul_f32 v99, s12, v99
    ds_read_b64_tr_b16 v[60:61], v5 offset:12288
    ds_read_b64_tr_b16 v[62:63], v5 offset:13312
    s_waitcnt lgkmcnt(6)
    v_mfma_f32_32x32x16_bf16 v[64:79], v[136:139], v[48:51], v[64:79]
    v_mul_f32 v100, s12, v100
    v_mul_f32 v101, s12, v101
    ds_read_b64_tr_b16 v[48:49], v4 offset:16384
    ds_read_b64_tr_b16 v[50:51], v4 offset:17408
    s_waitcnt lgkmcnt(6)
    v_mfma_f32_32x32x16_bf16 v[80:95], v[136:139], v[52:55], v[80:95]
    v_mul_f32 v102, s12, v102
    v_mul_f32 v103, s12, v103
    ds_read_b64_tr_b16 v[52:53], v5 offset:16384
    ds_read_b64_tr_b16 v[54:55], v5 offset:17408
    s_waitcnt lgkmcnt(6)
    v_mfma_f32_32x32x16_bf16 v[64:79], v[140:143], v[56:59], v[64:79]
    v_mul_f32 v104, s12, v104
    v_mul_f32 v105, s12, v105
    ds_read_b64_tr_b16 v[56:57], v4 offset:20480
    ds_read_b64_tr_b16 v[58:59], v4 offset:21504
    s_waitcnt lgkmcnt(6)
    v_mfma_f32_32x32x16_bf16 v[80:95], v[140:143], v[60:63], v[80:95]
    v_mul_f32 v106, s12, v106
    v_mul_f32 v107, s12, v107
    s_waitcnt vmcnt(9)
    s_barrier
    ds_read_b64_tr_b16 v[60:61], v5 offset:20480
    ds_read_b64_tr_b16 v[62:63], v5 offset:21504
    s_waitcnt lgkmcnt(6)
    v_mfma_f32_32x32x16_bf16 v[64:79], v[144:147], v[48:51], v[64:79]
    s_add_u32 m0, s10, 28672
    s_add_u32 s73, s8, 0
    buffer_load_dwordx4 v3, s[44:47], s73 offen lds
    v_mul_f32 v108, s12, v108
    v_mul_f32 v109, s12, v109
    ds_read_b64_tr_b16 v[48:49], v4 offset:24576
    ds_read_b64_tr_b16 v[50:51], v4 offset:25600
    s_waitcnt lgkmcnt(6)
    v_mfma_f32_32x32x16_bf16 v[80:95], v[144:147], v[52:55], v[80:95]
    s_add_u32 m0, s10, 32768
    s_add_u32 s73, s8, 114688
    buffer_load_dwordx4 v3, s[44:47], s73 offen lds
    v_mul_f32 v110, s12, v110
    v_mul_f32 v111, s12, v111
    ds_read_b64_tr_b16 v[52:53], v5 offset:24576
    ds_read_b64_tr_b16 v[54:55], v5 offset:25600
    s_waitcnt lgkmcnt(6)
    v_mfma_f32_32x32x16_bf16 v[64:79], v[148:151], v[56:59], v[64:79]
    s_add_u32 m0, s10, 36864
    s_add_u32 s73, s8, 229376
    buffer_load_dwordx4 v3, s[44:47], s73 offen lds
    v_cvt_pk_bf16_f32 v16, v96, v97
    v_cvt_pk_bf16_f32 v17, v98, v99
    v_add_u32 v4, 86016, v42
    v_add_u32 v5, 86016, v43
    ds_read_b64_tr_b16 v[56:57], v4 offset:0
    ds_read_b64_tr_b16 v[58:59], v4 offset:1024
    s_waitcnt lgkmcnt(6)
    v_mfma_f32_32x32x16_bf16 v[80:95], v[148:151], v[60:63], v[80:95]
    s_add_u32 m0, s11, 28672
    s_add_u32 s73, s9, 0
    s_mov_b32 exec_hi, 0
    buffer_load_dwordx4 v3, s[44:47], s73 offen lds
    s_mov_b32 exec_hi, -1
    v_cvt_pk_bf16_f32 v18, v100, v101
    v_cvt_pk_bf16_f32 v19, v102, v103
    ds_read_b64_tr_b16 v[60:61], v5 offset:0
    ds_read_b64_tr_b16 v[62:63], v5 offset:1024
    s_waitcnt lgkmcnt(6)
    v_mfma_f32_32x32x16_bf16 v[64:79], v[152:155], v[48:51], v[64:79]
    v_cvt_pk_bf16_f32 v20, v104, v105
    v_cvt_pk_bf16_f32 v21, v106, v107
    ds_read_b64_tr_b16 v[48:49], v4 offset:4096
    ds_read_b64_tr_b16 v[50:51], v4 offset:5120
    s_waitcnt lgkmcnt(6)
    v_mfma_f32_32x32x16_bf16 v[80:95], v[152:155], v[52:55], v[80:95]
    v_cvt_pk_bf16_f32 v22, v108, v109
    v_cvt_pk_bf16_f32 v23, v110, v111
    ds_read_b64_tr_b16 v[52:53], v5 offset:4096
    ds_read_b64_tr_b16 v[54:55], v5 offset:5120
    s_waitcnt lgkmcnt(6)
    v_mfma_f32_32x32x16_bf16 v[64:79], v[156:159], v[56:59], v[64:79]
    v_and_b32 v22, v22, v7
    v_and_b32 v23, v23, v7
    s_mul_i32 s87, s86, 147456
    ds_read_b64_tr_b16 v[56:57], v4 offset:8192
    ds_read_b64_tr_b16 v[58:59], v4 offset:9216
    s_waitcnt lgkmcnt(6)
    v_mfma_f32_32x32x16_bf16 v[80:95], v[156:159], v[60:63], v[80:95]
    s_lshl_b32 s96, s18, 11
    s_add_u32 s87, s87, s96
    buffer_store_dwordx4 v[16:19], v13, s[48:51], s14 offen sc1
    buffer_store_dwordx4 v[20:23], v13, s[48:51], s14 offen offset:1024 sc1
    ds_read_b64_tr_b16 v[60:61], v5 offset:8192
    ds_read_b64_tr_b16 v[62:63], v5 offset:9216
    s_waitcnt lgkmcnt(6)
    v_mfma_f32_32x32x16_bf16 v[64:79], v[160:163], v[48:51], v[64:79]
    s_add_u32 s87, s87, s85
    s_add_u32 s87, s87, 8503296
    ds_read_b64_tr_b16 v[48:49], v4 offset:12288
    ds_read_b64_tr_b16 v[50:51], v4 offset:13312
    s_waitcnt lgkmcnt(6)
    v_mfma_f32_32x32x16_bf16 v[80:95], v[160:163], v[52:55], v[80:95]
    v_and_b32 v45, 3, v1
    v_bfe_u32 v24, v1, 2, 1
    ds_read_b64_tr_b16 v[52:53], v5 offset:12288
    ds_read_b64_tr_b16 v[54:55], v5 offset:13312
    s_waitcnt lgkmcnt(6)
    v_mfma_f32_32x32x16_bf16 v[64:79], v[164:167], v[56:59], v[64:79]
    v_lshl_or_b32 v45, v24, 3, v45
    v_bfe_u32 v24, v1, 3, 1
    ds_read_b64_tr_b16 v[56:57], v4 offset:16384
    ds_read_b64_tr_b16 v[58:59], v4 offset:17408
    s_waitcnt lgkmcnt(6)
    v_mfma_f32_32x32x16_bf16 v[80:95], v[164:167], v[60:63], v[80:95]
    v_lshl_or_b32 v45, v24, 2, v45
    s_lshl_b32 s96, s92, 4
    ds_read_b64_tr_b16 v[60:61], v5 offset:16384
    ds_read_b64_tr_b16 v[62:63], v5 offset:17408
    s_waitcnt lgkmcnt(6)
    v_mfma_f32_32x32x16_bf16 v[64:79], v[168:171], v[48:51], v[64:79]
    v_add_u32 v45, s96, v45
    v_lshlrev_b32 v24, 3, v25
    ds_read_b64_tr_b16 v[48:49], v4 offset:20480
    ds_read_b64_tr_b16 v[50:51], v4 offset:21504
    s_waitcnt lgkmcnt(6)
    v_mfma_f32_32x32x16_bf16 v[80:95], v[168:171], v[52:55], v[80:95]
    v_sub_u32 v45, v45, v24
    s_lshr_b32 s90, s68, 2
    s_waitcnt vmcnt(11)
    s_barrier
    ds_read_b64_tr_b16 v[52:53], v5 offset:20480
    ds_read_b64_tr_b16 v[54:55], v5 offset:21504
    s_waitcnt lgkmcnt(6)
    v_mfma_f32_32x32x16_bf16 v[64:79], v[172:175], v[56:59], v[64:79]
    s_add_u32 m0, s10, 57344
    s_add_u32 s73, s8, 401408
    buffer_load_dwordx4 v3, s[44:47], s73 offen lds
    s_bfe_u32 s91, s68, 0x10001
    v_lshrrev_b32 v24, 3, v1
    ds_read_b64_tr_b16 v[56:57], v4 offset:24576
    ds_read_b64_tr_b16 v[58:59], v4 offset:25600
    s_waitcnt lgkmcnt(6)
    v_mfma_f32_32x32x16_bf16 v[80:95], v[172:175], v[60:63], v[80:95]
    s_add_u32 m0, s10, 61440
    s_add_u32 s73, s8, 516096
    buffer_load_dwordx4 v3, s[44:47], s73 offen lds
    v_and_b32 v25, 7, v1
    v_bfe_u32 v26, v1, 4, 1
    ds_read_b64_tr_b16 v[60:61], v5 offset:24576
    ds_read_b64_tr_b16 v[62:63], v5 offset:25600
    s_waitcnt lgkmcnt(6)
    v_mfma_f32_32x32x16_bf16 v[64:79], v[176:179], v[48:51], v[64:79]
    s_add_u32 m0, s10, 65536
    s_add_u32 s73, s8, 630784
    buffer_load_dwordx4 v3, s[44:47], s73 offen lds
    v_lshlrev_b32 v27, 2, v26
    v_xor_b32 v27, v27, v25
    v_add_u32 v4, 114688, v42
    v_add_u32 v5, 114688, v43
    ds_read_b64_tr_b16 v[48:49], v4 offset:0
    ds_read_b64_tr_b16 v[50:51], v4 offset:1024
    s_waitcnt lgkmcnt(6)
    v_mfma_f32_32x32x16_bf16 v[80:95], v[176:179], v[52:55], v[80:95]
    s_add_u32 m0, s11, 57344
    s_add_u32 s73, s9, 401408
    s_mov_b32 exec_hi, 0
    buffer_load_dwordx4 v3, s[44:47], s73 offen lds
    s_mov_b32 exec_hi, -1
    v_mul_u32_u24 v44, 896, v24
    v_lshl_add_u32 v44, v27, 4, v44
    ds_read_b64_tr_b16 v[52:53], v5 offset:0
    ds_read_b64_tr_b16 v[54:55], v5 offset:1024
    s_waitcnt lgkmcnt(6)
    v_mfma_f32_32x32x16_bf16 v[64:79], v[180:183], v[56:59], v[64:79]
    s_lshl_b32 s29, s68, 11
    s_add_u32 s30, s29, 65536
    ds_read_b64_tr_b16 v[56:57], v4 offset:4096
    ds_read_b64_tr_b16 v[58:59], v4 offset:5120
    s_waitcnt lgkmcnt(6)
    v_mfma_f32_32x32x16_bf16 v[80:95], v[180:183], v[60:63], v[80:95]
    s_mul_i32 s95, s68, 14336
    s_lshl_b32 s96, s89, 7
    s_add_u32 s95, s95, s96
    ds_read_b64_tr_b16 v[60:61], v5 offset:4096
    ds_read_b64_tr_b16 v[62:63], v5 offset:5120
    s_waitcnt lgkmcnt(6)
    v_mfma_f32_32x32x16_bf16 v[64:79], v[184:187], v[48:51], v[64:79]
    s_lshr_b32 s28, s68, 1
    s_mul_i32 s28, s28, 28
    ds_read_b64_tr_b16 v[48:49], v4 offset:8192
    ds_read_b64_tr_b16 v[50:51], v4 offset:9216
    s_waitcnt lgkmcnt(6)
    v_mfma_f32_32x32x16_bf16 v[80:95], v[184:187], v[52:55], v[80:95]
    s_lshl4_add_u32 s28, s92, s28
    s_mul_i32 s28, s28, 896
    ds_read_b64_tr_b16 v[52:53], v5 offset:8192
    ds_read_b64_tr_b16 v[54:55], v5 offset:9216
    s_waitcnt lgkmcnt(6)
    v_mfma_f32_32x32x16_bf16 v[64:79], v[188:191], v[56:59], v[64:79]
    s_add_u32 s28, s28, s96
    s_lshl1_add_u32 s97, s88, s91
    ds_read_b64_tr_b16 v[56:57], v4 offset:12288
    ds_read_b64_tr_b16 v[58:59], v4 offset:13312
    s_waitcnt lgkmcnt(6)
    v_mfma_f32_32x32x16_bf16 v[80:95], v[188:191], v[60:63], v[80:95]
    s_mul_i32 s31, s97, 28672
    s_add_u32 s31, s31, s96
    s_lshl3_add_u32 s74, s2, s68
    s_mul_i32 s74, s74, 7
    v_min_u32 v246, 6, v1
    v_add_lshl_u32 v246, v246, s74, 7
    s_mov_b64 exec, 127
    buffer_load_dword v247, v246, s[52:55], 0 offen
    s_mov_b64 exec, -1
    s_lshl3_add_u32 s74, s2, s68
    s_mul_i32 s74, s74, 2
    v_min_u32 v246, 1, v1
    v_add_lshl_u32 v246, v246, s74, 7
    s_mov_b64 exec, 3
    buffer_load_dword v247, v246, s[56:59], 0 offen
    s_mov_b64 exec, -1
    ds_read_b64_tr_b16 v[60:61], v5 offset:12288
    ds_read_b64_tr_b16 v[62:63], v5 offset:13312
    s_waitcnt lgkmcnt(6)
    v_mfma_f32_32x32x16_bf16 v[64:79], v[192:195], v[48:51], v[64:79]
    s_lshl_b32 s96, s92, 6
    s_add_u32 s31, s31, s96
    ds_read_b64_tr_b16 v[48:49], v4 offset:16384
    ds_read_b64_tr_b16 v[50:51], v4 offset:17408
    s_waitcnt lgkmcnt(6)
    v_mfma_f32_32x32x16_bf16 v[80:95], v[192:195], v[52:55], v[80:95]
    s_lshl_b32 s96, s90, 5
    s_add_u32 s31, s31, s96
    ds_read_b64_tr_b16 v[52:53], v5 offset:16384
    ds_read_b64_tr_b16 v[54:55], v5 offset:17408
    s_waitcnt lgkmcnt(6)
    v_mfma_f32_32x32x16_bf16 v[64:79], v[196:199], v[56:59], v[64:79]
    s_lshl_b32 s96, s89, 2
    s_lshr_b32 s96, 0x0, s96
    ds_read_b64_tr_b16 v[56:57], v4 offset:20480
    ds_read_b64_tr_b16 v[58:59], v4 offset:21504
    s_waitcnt lgkmcnt(6)
    v_mfma_f32_32x32x16_bf16 v[80:95], v[196:199], v[60:63], v[80:95]
    s_and_b32 s96, s96, 15
    s_lshl_b32 s94, s96, 13
    s_waitcnt vmcnt(12)
    s_barrier
    s_mov_b32 s76, 0
    s_nop 6
L_nz3:
    v_readfirstlane_b32 s75, v248
    s_nop 0
    s_cmp_lg_u32 s75, 0
    s_nop 2
    s_cbranch_scc1 L_nz_done3
    s_add_u32 s76, s76, 1
    s_cmp_gt_u32 s76, 100000
    s_cbranch_scc1 L_nz_done3
    s_sleep 2
    buffer_load_dwordx2 v[248:249], v251, s[64:67], 0 offen sc1
    s_waitcnt vmcnt(0)
    s_branch L_nz3
L_nz_done3:
    ds_read_b64_tr_b16 v[60:61], v5 offset:20480
    ds_read_b64_tr_b16 v[62:63], v5 offset:21504
    s_waitcnt lgkmcnt(6)
    v_mfma_f32_32x32x16_bf16 v[64:79], v[200:203], v[48:51], v[64:79]
    s_add_u32 m0, s10, 86016
    s_add_u32 s73, s8, 802816
    buffer_load_dwordx4 v3, s[44:47], s73 offen lds
    s_mul_i32 s96, s96, 114688
    s_add_u32 s95, s95, s96
    ds_read_b64_tr_b16 v[48:49], v4 offset:24576
    ds_read_b64_tr_b16 v[50:51], v4 offset:25600
    s_waitcnt lgkmcnt(6)
    v_mfma_f32_32x32x16_bf16 v[80:95], v[200:203], v[52:55], v[80:95]
    s_add_u32 m0, s10, 90112
    s_add_u32 s73, s8, 917504
    buffer_load_dwordx4 v3, s[44:47], s73 offen lds
    s_and_b32 s96, s88, 3
    s_lshl_b32 s97, s96, 2
    ds_read_b64_tr_b16 v[52:53], v5 offset:24576
    ds_read_b64_tr_b16 v[54:55], v5 offset:25600
    s_waitcnt lgkmcnt(6)
    v_mfma_f32_32x32x16_bf16 v[64:79], v[204:207], v[56:59], v[64:79]
    s_add_u32 m0, s10, 94208
    s_add_u32 s73, s8, 1032192
    buffer_load_dwordx4 v3, s[44:47], s73 offen lds
    s_lshr_b32 s97, 0x0, s97
    s_and_b32 s97, s97, 15
    v_add_u32 v4, 0, v42
    v_add_u32 v5, 0, v43
    ds_read_b64_tr_b16 v[56:57], v4 offset:0
    ds_read_b64_tr_b16 v[58:59], v4 offset:1024
    s_waitcnt lgkmcnt(6)
    v_mfma_f32_32x32x16_bf16 v[80:95], v[204:207], v[60:63], v[80:95]
    s_add_u32 m0, s11, 86016
    s_add_u32 s73, s9, 802816
    s_mov_b32 exec_hi, 0
    buffer_load_dwordx4 v3, s[44:47], s73 offen lds
    s_mov_b32 exec_hi, -1
    s_mul_i32 s97, s97, 896
    s_add_u32 s96, s96, s97
    ds_read_b64_tr_b16 v[60:61], v5 offset:0
    ds_read_b64_tr_b16 v[62:63], v5 offset:1024
    s_waitcnt lgkmcnt(6)
    v_mfma_f32_32x32x16_bf16 v[64:79], v[208:211], v[48:51], v[64:79]
    s_lshl_b32 s96, s96, 7
    s_mul_i32 s97, s68, 14336
    s_add_u32 s96, s96, s97
    ds_read_b64_tr_b16 v[48:49], v4 offset:4096
    ds_read_b64_tr_b16 v[50:51], v4 offset:5120
    s_waitcnt lgkmcnt(6)
    v_mfma_f32_32x32x16_bf16 v[80:95], v[208:211], v[52:55], v[80:95]
    s_add_u32 s96, s96, 688128
    s_cmp_ge_u32 s89, 7
    s_cselect_b32 s95, s96, s95
    ds_read_b64_tr_b16 v[52:53], v5 offset:4096
    ds_read_b64_tr_b16 v[54:55], v5 offset:5120
    s_waitcnt lgkmcnt(6)
    v_mfma_f32_32x32x16_bf16 v[64:79], v[212:215], v[56:59], v[64:79]
    s_lshl1_add_u32 s93, s88, s90
    s_mul_i32 s93, s93, 147456
    ds_read_b64_tr_b16 v[56:57], v4 offset:8192
    ds_read_b64_tr_b16 v[58:59], v4 offset:9216
    s_waitcnt lgkmcnt(6)
    v_mfma_f32_32x32x16_bf16 v[80:95], v[212:215], v[60:63], v[80:95]
    s_lshl_b32 s96, s72, 11
    s_add_u32 s93, s93, s96
    ds_read_b64_tr_b16 v[60:61], v5 offset:8192
    ds_read_b64_tr_b16 v[62:63], v5 offset:9216
    s_waitcnt lgkmcnt(6)
    v_mfma_f32_32x32x16_bf16 v[64:79], v[216:219], v[48:51], v[64:79]
    s_add_u32 s93, s93, 8388608
    ds_read_b64_tr_b16 v[48:49], v4 offset:12288
    ds_read_b64_tr_b16 v[50:51], v4 offset:13312
    s_waitcnt lgkmcnt(6)
    v_mfma_f32_32x32x16_bf16 v[80:95], v[216:219], v[52:55], v[80:95]
    ds_read_b64_tr_b16 v[52:53], v5 offset:12288
    ds_read_b64_tr_b16 v[54:55], v5 offset:13312
    s_waitcnt lgkmcnt(6)
    v_mfma_f32_32x32x16_bf16 v[64:79], v[220:223], v[56:59], v[64:79]
    ds_read_b64_tr_b16 v[56:57], v4 offset:16384
    ds_read_b64_tr_b16 v[58:59], v4 offset:17408
    s_waitcnt lgkmcnt(6)
    v_mfma_f32_32x32x16_bf16 v[80:95], v[220:223], v[60:63], v[80:95]
    ds_read_b64_tr_b16 v[60:61], v5 offset:16384
    ds_read_b64_tr_b16 v[62:63], v5 offset:17408
    s_waitcnt lgkmcnt(6)
    v_mfma_f32_32x32x16_bf16 v[64:79], v[224:227], v[48:51], v[64:79]
    ds_read_b64_tr_b16 v[48:49], v4 offset:20480
    ds_read_b64_tr_b16 v[50:51], v4 offset:21504
    s_waitcnt lgkmcnt(6)
    v_mfma_f32_32x32x16_bf16 v[80:95], v[224:227], v[52:55], v[80:95]
    s_waitcnt vmcnt(10)
    s_barrier
    s_add_u32 s75, s20, 0
    buffer_store_dwordx2 v[248:249], v252, s[48:51], s75 offen sc1
    ds_read_b64_tr_b16 v[52:53], v5 offset:20480
    ds_read_b64_tr_b16 v[54:55], v5 offset:21504
    s_waitcnt lgkmcnt(6)
    v_mfma_f32_32x32x16_bf16 v[64:79], v[228:231], v[56:59], v[64:79]
    s_add_u32 m0, s10, 114688
    s_add_u32 s73, s8, 1204224
    buffer_load_dwordx4 v3, s[44:47], s73 offen lds
    ds_read_b64_tr_b16 v[56:57], v4 offset:24576
    ds_read_b64_tr_b16 v[58:59], v4 offset:25600
    s_waitcnt lgkmcnt(6)
    v_mfma_f32_32x32x16_bf16 v[80:95], v[228:231], v[60:63], v[80:95]
    s_add_u32 m0, s10, 118784
    s_add_u32 s73, s8, 1318912
    buffer_load_dwordx4 v3, s[44:47], s73 offen lds
    ds_read_b64_tr_b16 v[60:61], v5 offset:24576
    ds_read_b64_tr_b16 v[62:63], v5 offset:25600
    s_waitcnt lgkmcnt(6)
    v_mfma_f32_32x32x16_bf16 v[64:79], v[232:235], v[48:51], v[64:79]
    s_add_u32 m0, s10, 122880
    s_add_u32 s73, s8, 1433600
    buffer_load_dwordx4 v3, s[44:47], s73 offen lds
    v_add_u32 v4, 28672, v11
    ds_read_b64_tr_b16 v[48:49], v4 offset:0
    ds_read_b64_tr_b16 v[50:51], v4 offset:512
    s_waitcnt lgkmcnt(6)
    v_mfma_f32_32x32x16_bf16 v[80:95], v[232:235], v[52:55], v[80:95]
    s_add_u32 m0, s11, 114688
    s_add_u32 s73, s9, 1204224
    s_mov_b32 exec_hi, 0
    buffer_load_dwordx4 v3, s[44:47], s73 offen lds
    s_mov_b32 exec_hi, -1
    ds_read_b64_tr_b16 v[52:53], v4 offset:2048
    ds_read_b64_tr_b16 v[54:55], v4 offset:2560
    s_waitcnt lgkmcnt(6)
    v_mfma_f32_32x32x16_bf16 v[64:79], v[236:239], v[56:59], v[64:79]
    ds_read_b64_tr_b16 v[56:57], v4 offset:4096
    ds_read_b64_tr_b16 v[58:59], v4 offset:4608
    s_waitcnt lgkmcnt(6)
    v_mfma_f32_32x32x16_bf16 v[80:95], v[236:239], v[60:63], v[80:95]
    ds_read_b64_tr_b16 v[60:61], v4 offset:6144
    ds_read_b64_tr_b16 v[62:63], v4 offset:6656
    s_waitcnt lgkmcnt(6)
    v_mfma_f32_32x32x16_bf16 v[96:111], v[48:51], v[128:131], 0
    ds_read_b64_tr_b16 v[48:49], v4 offset:8192
    ds_read_b64_tr_b16 v[50:51], v4 offset:8704
    s_waitcnt lgkmcnt(6)
    v_mfma_f32_32x32x16_bf16 v[96:111], v[52:55], v[132:135], v[96:111]
    ds_read_b64_tr_b16 v[52:53], v4 offset:10240
    ds_read_b64_tr_b16 v[54:55], v4 offset:10752
    s_waitcnt lgkmcnt(6)
    v_mfma_f32_32x32x16_bf16 v[96:111], v[56:59], v[136:139], v[96:111]
    v_cvt_pk_bf16_f32 v16, v64, v65
    v_cvt_pk_bf16_f32 v17, v66, v67
    v_cvt_pk_bf16_f32 v18, v68, v69
    s_waitcnt vmcnt(11)
    s_barrier
    ds_read_b64_tr_b16 v[56:57], v4 offset:12288
    ds_read_b64_tr_b16 v[58:59], v4 offset:12800
    s_waitcnt lgkmcnt(6)
    v_mfma_f32_32x32x16_bf16 v[96:111], v[60:63], v[140:143], v[96:111]
    v_cvt_pk_bf16_f32 v19, v70, v71
    v_cvt_pk_bf16_f32 v20, v72, v73
    v_cvt_pk_bf16_f32 v21, v74, v75
    v_add_u32 v4, 57344, v11
    ds_read_b64_tr_b16 v[60:61], v4 offset:0
    ds_read_b64_tr_b16 v[62:63], v4 offset:512
    s_waitcnt lgkmcnt(6)
    v_mfma_f32_32x32x16_bf16 v[96:111], v[48:51], v[144:147], v[96:111]
    v_cvt_pk_bf16_f32 v22, v76, v77
    v_cvt_pk_bf16_f32 v23, v78, v79
    v_cndmask_b32 v16, v16, v245, s[16:17]
    ds_read_b64_tr_b16 v[48:49], v4 offset:2048
    ds_read_b64_tr_b16 v[50:51], v4 offset:2560
    s_waitcnt lgkmcnt(6)
    v_mfma_f32_32x32x16_bf16 v[96:111], v[52:55], v[148:151], v[96:111]
    v_cndmask_b32 v17, v17, v245, s[16:17]
    v_cndmask_b32 v18, v18, v245, s[16:17]
    v_cndmask_b32 v19, v19, v245, s[16:17]
    ds_read_b64_tr_b16 v[52:53], v4 offset:4096
    ds_read_b64_tr_b16 v[54:55], v4 offset:4608
    s_waitcnt lgkmcnt(6)
    v_mfma_f32_32x32x16_bf16 v[96:111], v[56:59], v[152:155], v[96:111]
    v_cndmask_b32 v20, v20, v245, s[16:17]
    v_cndmask_b32 v21, v21, v245, s[16:17]
    v_cndmask_b32 v22, v22, v245, s[16:17]
    ds_read_b64_tr_b16 v[56:57], v4 offset:6144
    ds_read_b64_tr_b16 v[58:59], v4 offset:6656
    s_waitcnt lgkmcnt(6)
    v_mfma_f32_32x32x16_bf16 v[96:111], v[60:63], v[156:159], v[96:111]
    v_cndmask_b32 v23, v23, v245, s[16:17]
    buffer_store_dwordx4 v[16:19], v6, s[48:51], s15 offen sc1
    buffer_store_dwordx4 v[20:23], v6, s[48:51], s15 offen offset:1024 sc1
    ds_read_b64_tr_b16 v[60:61], v4 offset:8192
    ds_read_b64_tr_b16 v[62:63], v4 offset:8704
    s_waitcnt lgkmcnt(6)
    v_mfma_f32_32x32x16_bf16 v[96:111], v[48:51], v[160:163], v[96:111]
    v_cvt_pk_bf16_f32 v24, v80, v81
    v_cvt_pk_bf16_f32 v25, v82, v83
    v_cvt_pk_bf16_f32 v26, v84, v85
    ds_read_b64_tr_b16 v[48:49], v4 offset:10240
    ds_read_b64_tr_b16 v[50:51], v4 offset:10752
    s_waitcnt lgkmcnt(6)
    v_mfma_f32_32x32x16_bf16 v[96:111], v[52:55], v[164:167], v[96:111]
    v_cvt_pk_bf16_f32 v27, v86, v87
    v_cvt_pk_bf16_f32 v28, v88, v89
    v_cvt_pk_bf16_f32 v29, v90, v91
    s_waitcnt vmcnt(7)
    s_barrier
    ds_read_b64_tr_b16 v[52:53], v4 offset:12288
    ds_read_b64_tr_b16 v[54:55], v4 offset:12800
    s_waitcnt lgkmcnt(6)
    v_mfma_f32_32x32x16_bf16 v[96:111], v[56:59], v[168:171], v[96:111]
    v_cvt_pk_bf16_f32 v30, v92, v93
    v_cvt_pk_bf16_f32 v31, v94, v95
    v_cndmask_b32 v24, v24, v245, s[16:17]
    v_add_u32 v4, 86016, v11
    ds_read_b64_tr_b16 v[56:57], v4 offset:0
    ds_read_b64_tr_b16 v[58:59], v4 offset:512
    s_waitcnt lgkmcnt(6)
    v_mfma_f32_32x32x16_bf16 v[96:111], v[60:63], v[172:175], v[96:111]
    v_cndmask_b32 v25, v25, v245, s[16:17]
    v_cndmask_b32 v26, v26, v245, s[16:17]
    v_cndmask_b32 v27, v27, v245, s[16:17]
    ds_read_b64_tr_b16 v[60:61], v4 offset:2048
    ds_read_b64_tr_b16 v[62:63], v4 offset:2560
    s_waitcnt lgkmcnt(6)
    v_mfma_f32_32x32x16_bf16 v[96:111], v[48:51], v[176:179], v[96:111]
    v_cndmask_b32 v28, v28, v245, s[16:17]
    v_cndmask_b32 v29, v29, v245, s[16:17]
    v_cndmask_b32 v30, v30, v245, s[16:17]
    ds_read_b64_tr_b16 v[48:49], v4 offset:4096
    ds_read_b64_tr_b16 v[50:51], v4 offset:4608
    s_waitcnt lgkmcnt(6)
    v_mfma_f32_32x32x16_bf16 v[96:111], v[52:55], v[180:183], v[96:111]
    v_cndmask_b32 v31, v31, v245, s[16:17]
    s_add_u32 s15, s15, 131072
    buffer_store_dwordx4 v[24:27], v6, s[48:51], s15 offen sc1
    ds_read_b64_tr_b16 v[52:53], v4 offset:6144
    ds_read_b64_tr_b16 v[54:55], v4 offset:6656
    s_waitcnt lgkmcnt(6)
    v_mfma_f32_32x32x16_bf16 v[96:111], v[56:59], v[184:187], v[96:111]
    buffer_store_dwordx4 v[28:31], v6, s[48:51], s15 offen offset:1024 sc1
    ds_read_b64_tr_b16 v[56:57], v4 offset:8192
    ds_read_b64_tr_b16 v[58:59], v4 offset:8704
    s_waitcnt lgkmcnt(6)
    v_mfma_f32_32x32x16_bf16 v[96:111], v[60:63], v[188:191], v[96:111]
    ds_read_b64_tr_b16 v[60:61], v4 offset:10240
    ds_read_b64_tr_b16 v[62:63], v4 offset:10752
    s_waitcnt lgkmcnt(6)
    v_mfma_f32_32x32x16_bf16 v[96:111], v[48:51], v[192:195], v[96:111]
    s_waitcnt vmcnt(4)
    s_barrier
    ds_read_b64_tr_b16 v[48:49], v4 offset:12288
    ds_read_b64_tr_b16 v[50:51], v4 offset:12800
    s_waitcnt lgkmcnt(6)
    v_mfma_f32_32x32x16_bf16 v[96:111], v[52:55], v[196:199], v[96:111]
    v_add_u32 v4, 114688, v11
    ds_read_b64_tr_b16 v[52:53], v4 offset:0
    ds_read_b64_tr_b16 v[54:55], v4 offset:512
    s_waitcnt lgkmcnt(6)
    v_mfma_f32_32x32x16_bf16 v[96:111], v[56:59], v[200:203], v[96:111]
    ds_read_b64_tr_b16 v[56:57], v4 offset:2048
    ds_read_b64_tr_b16 v[58:59], v4 offset:2560
    s_waitcnt lgkmcnt(6)
    v_mfma_f32_32x32x16_bf16 v[96:111], v[60:63], v[204:207], v[96:111]
    v_and_b32 v246, 0x13, v1
    v_bfe_u32 v9, v1, 2, 1
    v_lshl_or_b32 v246, v9, 3, v246
    v_bfe_u32 v9, v1, 3, 1
    v_lshl_or_b32 v246, v9, 2, v246
    v_mul_u32_u24 v246, 896, v246
    v_lshrrev_b32 v9, 5, v1
    v_lshl_add_u32 v9, v9, 4, v246
    buffer_load_dwordx4 v[40:43], v9, s[36:39], s31 offen
    ds_read_b64_tr_b16 v[60:61], v4 offset:4096
    ds_read_b64_tr_b16 v[62:63], v4 offset:4608
    s_waitcnt lgkmcnt(6)
    v_mfma_f32_32x32x16_bf16 v[96:111], v[48:51], v[208:211], v[96:111]
    ds_read_b64_tr_b16 v[48:49], v4 offset:6144
    ds_read_b64_tr_b16 v[50:51], v4 offset:6656
    s_waitcnt lgkmcnt(6)
    v_mfma_f32_32x32x16_bf16 v[96:111], v[52:55], v[212:215], v[96:111]
    ds_read_b64_tr_b16 v[52:53], v4 offset:8192
    ds_read_b64_tr_b16 v[54:55], v4 offset:8704
    s_waitcnt lgkmcnt(6)
    v_mfma_f32_32x32x16_bf16 v[96:111], v[56:59], v[216:219], v[96:111]
    ds_read_b64_tr_b16 v[56:57], v4 offset:10240
    ds_read_b64_tr_b16 v[58:59], v4 offset:10752
    s_waitcnt lgkmcnt(6)
    v_mfma_f32_32x32x16_bf16 v[96:111], v[60:63], v[220:223], v[96:111]
    ds_read_b64_tr_b16 v[60:61], v4 offset:12288
    ds_read_b64_tr_b16 v[62:63], v4 offset:12800
    s_waitcnt lgkmcnt(6)
    v_mfma_f32_32x32x16_bf16 v[96:111], v[48:51], v[224:227], v[96:111]
    s_add_u32 m0, s30, 81920
    s_add_u32 s73, s95, 573440
    s_sub_u32 s0, s73, 1605632
    s_min_u32 s73, s73, s0
    buffer_load_dwordx4 v44, s[52:55], s73 offen lds
    v_add_u32 v5, 28672, v12
    ds_read_b64_tr_b16 v[48:49], v5 offset:0
    ds_read_b64_tr_b16 v[50:51], v5 offset:512
    s_waitcnt lgkmcnt(6)
    v_mfma_f32_32x32x16_bf16 v[96:111], v[52:55], v[228:231], v[96:111]
    s_add_u32 m0, s30, 82944
    s_add_u32 s73, s95, 580608
    s_sub_u32 s0, s73, 1605632
    s_min_u32 s73, s73, s0
    buffer_load_dwordx4 v44, s[52:55], s73 offen lds
    buffer_load_dwordx2 v[254:255], v253, s[48:51], 0 offen sc1
    ds_read_b64_tr_b16 v[52:53], v5 offset:2048
    ds_read_b64_tr_b16 v[54:55], v5 offset:2560
    s_waitcnt lgkmcnt(6)
    v_mfma_f32_32x32x16_bf16 v[96:111], v[56:59], v[232:235], v[96:111]
    ds_read_b64_tr_b16 v[56:57], v5 offset:4096
    ds_read_b64_tr_b16 v[58:59], v5 offset:4608
    s_waitcnt lgkmcnt(6)
    v_mfma_f32_32x32x16_bf16 v[96:111], v[60:63], v[236:239], v[96:111]
    s_waitcnt vmcnt(4)
    s_barrier
    s_add_u32 s75, s20, 6144
    buffer_store_dwordx2 v[248:249], v252, s[48:51], s75 offen sc1
    ds_read_b64_tr_b16 v[60:61], v5 offset:6144
    ds_read_b64_tr_b16 v[62:63], v5 offset:6656
    s_waitcnt lgkmcnt(6)
    v_mfma_f32_32x32x16_bf16 v[112:127], v[48:51], v[128:131], 0
    ds_read_b64_tr_b16 v[48:49], v5 offset:8192
    ds_read_b64_tr_b16 v[50:51], v5 offset:8704
    s_waitcnt lgkmcnt(6)
    v_mfma_f32_32x32x16_bf16 v[112:127], v[52:55], v[132:135], v[112:127]
    ds_read_b64_tr_b16 v[52:53], v5 offset:10240
    ds_read_b64_tr_b16 v[54:55], v5 offset:10752
    s_waitcnt lgkmcnt(6)
    v_mfma_f32_32x32x16_bf16 v[112:127], v[56:59], v[136:139], v[112:127]
    v_mul_f32 v16, v96, v96
    v_mul_f32 v17, v97, v97
    v_mul_f32 v18, v98, v98
    v_mul_f32 v19, v99, v99
    v_mul_f32 v20, v100, v100
    ds_read_b64_tr_b16 v[56:57], v5 offset:12288
    ds_read_b64_tr_b16 v[58:59], v5 offset:12800
    s_waitcnt lgkmcnt(6)
    v_mfma_f32_32x32x16_bf16 v[112:127], v[60:63], v[140:143], v[112:127]
    v_mul_f32 v21, v101, v101
    v_mul_f32 v22, v102, v102
    v_mul_f32 v23, v103, v103
    v_add_u32 v5, 57344, v12
    ds_read_b64_tr_b16 v[60:61], v5 offset:0
    ds_read_b64_tr_b16 v[62:63], v5 offset:512
    s_waitcnt lgkmcnt(6)
    v_mfma_f32_32x32x16_bf16 v[112:127], v[48:51], v[144:147], v[112:127]
    v_fma_f32 v16, v16, v10, v8
    v_fma_f32 v17, v17, v10, v8
    v_fma_f32 v18, v18, v10, v8
    ds_read_b64_tr_b16 v[48:49], v5 offset:2048
    ds_read_b64_tr_b16 v[50:51], v5 offset:2560
    s_waitcnt lgkmcnt(6)
    v_mfma_f32_32x32x16_bf16 v[112:127], v[52:55], v[148:151], v[112:127]
    v_fma_f32 v19, v19, v10, v8
    v_fma_f32 v20, v20, v10, v8
    v_fma_f32 v21, v21, v10, v8
    ds_read_b64_tr_b16 v[52:53], v5 offset:4096
    ds_read_b64_tr_b16 v[54:55], v5 offset:4608
    s_waitcnt lgkmcnt(6)
    v_mfma_f32_32x32x16_bf16 v[112:127], v[56:59], v[152:155], v[112:127]
    v_fma_f32 v22, v22, v10, v8
    v_fma_f32 v23, v23, v10, v8
    v_mul_f32 v16, v16, v96
    ds_read_b64_tr_b16 v[56:57], v5 offset:6144
    ds_read_b64_tr_b16 v[58:59], v5 offset:6656
    s_waitcnt lgkmcnt(6)
    v_mfma_f32_32x32x16_bf16 v[112:127], v[60:63], v[156:159], v[112:127]
    v_mul_f32 v17, v17, v97
    v_mul_f32 v18, v18, v98
    v_mul_f32 v19, v19, v99
    ds_read_b64_tr_b16 v[60:61], v5 offset:8192
    ds_read_b64_tr_b16 v[62:63], v5 offset:8704
    s_waitcnt lgkmcnt(6)
    v_mfma_f32_32x32x16_bf16 v[112:127], v[48:51], v[160:163], v[112:127]
    v_mul_f32 v20, v20, v100
    v_mul_f32 v21, v21, v101
    v_mul_f32 v22, v22, v102
    ds_read_b64_tr_b16 v[48:49], v5 offset:10240
    ds_read_b64_tr_b16 v[50:51], v5 offset:10752
    s_waitcnt lgkmcnt(6)
    v_mfma_f32_32x32x16_bf16 v[112:127], v[52:55], v[164:167], v[112:127]
    v_mul_f32 v23, v23, v103
    v_exp_f32 v16, v16
    v_mul_f32 v96, v96, v104
    s_cmp_lg_u32 s68, 0
    s_nop 7
    s_cbranch_scc1 L_wf_done4
    s_mov_b32 s76, 0
    s_waitcnt vmcnt(1)
L_wf4:
    v_cmp_eq_u64 vcc, v[254:255], v[248:249]
    s_nop 0
    s_and_b32 s75, vcc_lo, 15
    s_cmp_eq_u32 s75, 15
    s_nop 1
    s_cbranch_scc1 L_wf_done4
    s_add_u32 s76, s76, 1
    s_cmp_gt_u32 s76, 100000
    s_cbranch_scc1 L_wf_done4
    s_sleep 4
    buffer_load_dwordx2 v[254:255], v253, s[48:51], 0 offen sc1
    s_waitcnt vmcnt(0)
    s_branch L_wf4
L_wf_done4:
    s_barrier
    ds_read_b64_tr_b16 v[52:53], v5 offset:12288
    ds_read_b64_tr_b16 v[54:55], v5 offset:12800
    s_waitcnt lgkmcnt(6)
    v_mfma_f32_32x32x16_bf16 v[112:127], v[56:59], v[168:171], v[112:127]
    s_mul_i32 s0, s68, 3072
    s_mov_b32 m0, s0
    s_add_u32 s73, s81, 2097152
    buffer_load_dwordx4 v6, s[48:51], s73 offen offset:0 sc1 lds
    s_add_u32 s73, s82, 2096128
    buffer_load_dwordx4 v6, s[48:51], s73 offen offset:1024 sc1 lds
    s_add_u32 s73, s83, 2095104
    buffer_load_dwordx4 v6, s[48:51], s73 offen offset:2048 sc1 lds
    v_exp_f32 v17, v17
    v_mul_f32 v97, v97, v105
    v_exp_f32 v18, v18
    v_add_u32 v5, 86016, v12
    ds_read_b64_tr_b16 v[56:57], v5 offset:0
    ds_read_b64_tr_b16 v[58:59], v5 offset:512
    s_waitcnt lgkmcnt(6)
    v_mfma_f32_32x32x16_bf16 v[112:127], v[60:63], v[172:175], v[112:127]
    s_lshr_b32 s0, s68, 1
    s_lshl_b32 s0, s0, 11
    s_add_u32 s0, s0, s85
    s_add_u32 s0, s0, s84
    buffer_load_dwordx4 v[240:243], v244, s[48:51], s0 offen sc1
    v_mul_f32 v98, v98, v106
    v_exp_f32 v19, v19
    v_mul_f32 v99, v99, v107
    ds_read_b64_tr_b16 v[60:61], v5 offset:2048
    ds_read_b64_tr_b16 v[62:63], v5 offset:2560
    s_waitcnt lgkmcnt(6)
    v_mfma_f32_32x32x16_bf16 v[112:127], v[48:51], v[176:179], v[112:127]
    v_exp_f32 v20, v20
    v_mul_f32 v100, v100, v108
    v_exp_f32 v21, v21
    ds_read_b64_tr_b16 v[48:49], v5 offset:4096
    ds_read_b64_tr_b16 v[50:51], v5 offset:4608
    s_waitcnt lgkmcnt(6)
    v_mfma_f32_32x32x16_bf16 v[112:127], v[52:55], v[180:183], v[112:127]
    v_mul_f32 v101, v101, v109
    v_exp_f32 v22, v22
    v_mul_f32 v102, v102, v110
    ds_read_b64_tr_b16 v[52:53], v5 offset:6144
    ds_read_b64_tr_b16 v[54:55], v5 offset:6656
    s_waitcnt lgkmcnt(6)
    v_mfma_f32_32x32x16_bf16 v[112:127], v[56:59], v[184:187], v[112:127]
    v_exp_f32 v23, v23
    v_mul_f32 v103, v103, v111
    v_add_f32 v16, 1.0, v16
    ds_read_b64_tr_b16 v[56:57], v5 offset:8192
    ds_read_b64_tr_b16 v[58:59], v5 offset:8704
    s_waitcnt lgkmcnt(6)
    v_mfma_f32_32x32x16_bf16 v[112:127], v[60:63], v[188:191], v[112:127]
    v_add_f32 v17, 1.0, v17
    v_add_f32 v18, 1.0, v18
    v_add_f32 v19, 1.0, v19
    buffer_load_dwordx2 v[254:255], v47, s[48:51], 0 offen sc1
    ds_read_b64_tr_b16 v[60:61], v5 offset:10240
    ds_read_b64_tr_b16 v[62:63], v5 offset:10752
    s_waitcnt lgkmcnt(6)
    v_mfma_f32_32x32x16_bf16 v[112:127], v[48:51], v[192:195], v[112:127]
    v_add_f32 v20, 1.0, v20
    v_add_f32 v21, 1.0, v21
    v_add_f32 v22, 1.0, v22
    ds_read_b64_tr_b16 v[48:49], v5 offset:12288
    ds_read_b64_tr_b16 v[50:51], v5 offset:12800
    s_waitcnt lgkmcnt(6)
    v_mfma_f32_32x32x16_bf16 v[112:127], v[52:55], v[196:199], v[112:127]
    v_add_f32 v23, 1.0, v23
    v_rcp_f32 v16, v16
    v_rcp_f32 v17, v17
    v_add_u32 v5, 114688, v12
    ds_read_b64_tr_b16 v[52:53], v5 offset:0
    ds_read_b64_tr_b16 v[54:55], v5 offset:512
    s_waitcnt lgkmcnt(6)
    v_mfma_f32_32x32x16_bf16 v[112:127], v[56:59], v[200:203], v[112:127]
    v_rcp_f32 v18, v18
    v_rcp_f32 v19, v19
    v_rcp_f32 v20, v20
    ds_read_b64_tr_b16 v[56:57], v5 offset:2048
    ds_read_b64_tr_b16 v[58:59], v5 offset:2560
    s_waitcnt lgkmcnt(6)
    v_mfma_f32_32x32x16_bf16 v[112:127], v[60:63], v[204:207], v[112:127]
    v_rcp_f32 v21, v21
    v_rcp_f32 v22, v22
    v_rcp_f32 v23, v23
    ds_read_b64_tr_b16 v[60:61], v5 offset:4096
    ds_read_b64_tr_b16 v[62:63], v5 offset:4608
    s_waitcnt lgkmcnt(6)
    v_mfma_f32_32x32x16_bf16 v[112:127], v[48:51], v[208:211], v[112:127]
    v_mul_f32 v96, v96, v16
    v_mul_f32 v97, v97, v17
    v_mul_f32 v98, v98, v18
    ds_read_b64_tr_b16 v[48:49], v5 offset:6144
    ds_read_b64_tr_b16 v[50:51], v5 offset:6656
    s_waitcnt lgkmcnt(6)
    v_mfma_f32_32x32x16_bf16 v[112:127], v[52:55], v[212:215], v[112:127]
    v_mul_f32 v99, v99, v19
    v_mul_f32 v100, v100, v20
    v_mul_f32 v101, v101, v21
    ds_read_b64_tr_b16 v[52:53], v5 offset:8192
    ds_read_b64_tr_b16 v[54:55], v5 offset:8704
    s_waitcnt lgkmcnt(6)
    v_mfma_f32_32x32x16_bf16 v[112:127], v[56:59], v[216:219], v[112:127]
    v_mul_f32 v102, v102, v22
    v_mul_f32 v103, v103, v23
    v_cvt_pk_bf16_f32 v24, v96, v97
    ds_read_b64_tr_b16 v[56:57], v5 offset:10240
    ds_read_b64_tr_b16 v[58:59], v5 offset:10752
    s_waitcnt lgkmcnt(6)
    v_mfma_f32_32x32x16_bf16 v[112:127], v[60:63], v[220:223], v[112:127]
    v_cvt_pk_bf16_f32 v25, v98, v99
    v_cvt_pk_bf16_f32 v26, v100, v101
    v_cvt_pk_bf16_f32 v27, v102, v103
    ds_read_b64_tr_b16 v[60:61], v5 offset:12288
    ds_read_b64_tr_b16 v[62:63], v5 offset:12800
    s_waitcnt lgkmcnt(6)
    v_mfma_f32_32x32x16_bf16 v[112:127], v[48:51], v[224:227], v[112:127]
    buffer_store_dwordx4 v[24:27], v6, s[48:51], s77 offen offset:0 sc1
    s_waitcnt lgkmcnt(4)
    v_mfma_f32_32x32x16_bf16 v[112:127], v[52:55], v[228:231], v[112:127]
    s_waitcnt lgkmcnt(2)
    v_mfma_f32_32x32x16_bf16 v[112:127], v[56:59], v[232:235], v[112:127]
    s_waitcnt lgkmcnt(0)
    v_mfma_f32_32x32x16_bf16 v[112:127], v[60:63], v[236:239], v[112:127]
    s_cmp_lg_u32 s68, 0
    s_nop 10
    s_cbranch_scc1 L_wf_done5
    s_mov_b32 s76, 0
    s_waitcnt vmcnt(1)
L_wf5:
    v_cmp_eq_u64 vcc, v[254:255], v[248:249]
    s_nop 0
    s_and_b32 s75, vcc_lo, 7
    s_cmp_eq_u32 s75, 7
    s_nop 1
    s_cbranch_scc1 L_wf_done5
    s_add_u32 s76, s76, 1
    s_cmp_gt_u32 s76, 100000
    s_cbranch_scc1 L_wf_done5
    s_sleep 4
    buffer_load_dwordx2 v[254:255], v47, s[48:51], 0 offen sc1
    s_waitcnt vmcnt(0)
    s_branch L_wf5
L_wf_done5:
    s_waitcnt vmcnt(2)
L_postA:
    s_lshr_b32 s76, s68, 1
    s_lshl_b32 s76, s76, 11
    v_add_u32 v3, s76, v244
    v_add_u32 v4, 24576, v3
    s_barrier
    ds_read_b128 v[204:207], v3 offset:0
    ds_read_b128 v[208:211], v3 offset:256
    ds_read_b128 v[212:215], v3 offset:2048
    ds_read_b128 v[216:219], v3 offset:2304
    ds_read_b128 v[220:223], v3 offset:4096
    ds_read_b128 v[224:227], v3 offset:4352
    s_mul_i32 s74, s68, 3072
    s_add_u32 m0, s74, 24576
    s_add_u32 s76, s81, 4194304
    buffer_load_dwordx4 v6, s[48:51], s76 offen offset:0 sc1 lds
    s_add_u32 s76, s82, 4193280
    buffer_load_dwordx4 v6, s[48:51], s76 offen offset:1024 sc1 lds
    s_add_u32 s76, s83, 4192256
    buffer_load_dwordx4 v6, s[48:51], s76 offen offset:2048 sc1 lds
    s_add_u32 m0, s30, 0
    s_add_u32 s73, s95, 0
    s_sub_u32 s0, s73, 1605632
    s_min_u32 s73, s73, s0
    buffer_load_dwordx4 v44, s[52:55], s73 offen lds
    s_add_u32 m0, s30, 1024
    s_add_u32 s73, s95, 7168
    s_sub_u32 s0, s73, 1605632
    s_min_u32 s73, s73, s0
    buffer_load_dwordx4 v44, s[52:55], s73 offen lds
    ds_read_b128 v[228:231], v3 offset:6144
    s_waitcnt lgkmcnt(6)
    v_mfma_f32_16x16x32_bf16 v[132:135], v[204:207], v[240:243], 0
    v_pk_mul_f32 v[28:29], v[112:113], v[112:113]
    v_pk_mul_f32 v[30:31], v[114:115], v[114:115]
    v_pk_mul_f32 v[32:33], v[116:117], v[116:117]
    v_pk_mul_f32 v[34:35], v[118:119], v[118:119]
    v_pk_fma_f32 v[28:29], v[28:29], v[10:11], v[8:9] op_sel_hi:[1,0,0]
    v_pk_fma_f32 v[30:31], v[30:31], v[10:11], v[8:9] op_sel_hi:[1,0,0]
    v_pk_fma_f32 v[32:33], v[32:33], v[10:11], v[8:9] op_sel_hi:[1,0,0]
    v_pk_fma_f32 v[34:35], v[34:35], v[10:11], v[8:9] op_sel_hi:[1,0,0]
    v_pk_mul_f32 v[28:29], v[28:29], v[112:113]
    v_pk_mul_f32 v[30:31], v[30:31], v[114:115]
    v_pk_mul_f32 v[32:33], v[32:33], v[116:117]
    ds_read_b128 v[232:235], v3 offset:6400
    s_waitcnt lgkmcnt(6)
    v_mfma_f32_16x16x32_bf16 v[136:139], v[208:211], v[240:243], 0
    v_pk_mul_f32 v[34:35], v[34:35], v[118:119]
    v_exp_f32 v28, v28
    v_exp_f32 v29, v29
    v_pk_mul_f32 v[112:113], v[112:113], v[120:121]
    v_exp_f32 v30, v30
    v_exp_f32 v31, v31
    v_pk_mul_f32 v[114:115], v[114:115], v[122:123]
    v_exp_f32 v32, v32
    v_exp_f32 v33, v33
    v_pk_mul_f32 v[116:117], v[116:117], v[124:125]
    v_exp_f32 v34, v34
    ds_read_b128 v[204:207], v3 offset:8192
    s_waitcnt lgkmcnt(6)
    v_mfma_f32_16x16x32_bf16 v[140:143], v[212:215], v[240:243], 0
    v_exp_f32 v35, v35
    v_pk_mul_f32 v[118:119], v[118:119], v[126:127]
    v_pk_add_f32 v[28:29], v[28:29], v[14:15] op_sel_hi:[1,0]
    v_pk_add_f32 v[30:31], v[30:31], v[14:15] op_sel_hi:[1,0]
    v_pk_add_f32 v[32:33], v[32:33], v[14:15] op_sel_hi:[1,0]
    v_pk_add_f32 v[34:35], v[34:35], v[14:15] op_sel_hi:[1,0]
    v_rcp_f32 v28, v28
    v_rcp_f32 v29, v29
    v_rcp_f32 v30, v30
    v_rcp_f32 v31, v31
    v_rcp_f32 v32, v32
    ds_read_b128 v[208:211], v3 offset:8448
    s_waitcnt lgkmcnt(6)
    v_mfma_f32_16x16x32_bf16 v[144:147], v[216:219], v[240:243], 0
    v_rcp_f32 v33, v33
    v_rcp_f32 v34, v34
    v_rcp_f32 v35, v35
    v_pk_mul_f32 v[112:113], v[112:113], v[28:29]
    v_pk_mul_f32 v[114:115], v[114:115], v[30:31]
    v_pk_mul_f32 v[116:117], v[116:117], v[32:33]
    v_pk_mul_f32 v[118:119], v[118:119], v[34:35]
    v_cvt_pk_bf16_f32 v36, v112, v113
    v_cvt_pk_bf16_f32 v37, v114, v115
    v_cvt_pk_bf16_f32 v38, v116, v117
    v_cvt_pk_bf16_f32 v39, v118, v119
    buffer_store_dwordx4 v[36:39], v6, s[48:51], s77 offen offset:1024 sc1
    ds_read_b128 v[212:215], v3 offset:10240
    s_waitcnt lgkmcnt(6)
    v_mfma_f32_16x16x32_bf16 v[148:151], v[220:223], v[240:243], 0
    v_cmp_le_i32 s[24:25], 0, v45
    v_cmp_le_i32 s[26:27], 1, v45
    v_cmp_le_i32 s[16:17], 2, v45
    v_cmp_le_i32 s[64:65], 3, v45
    v_cmp_le_i32 s[32:33], 4, v45
    v_cmp_le_i32 s[34:35], 5, v45
    v_cmp_le_i32 s[40:41], 6, v45
    v_cmp_le_i32 s[42:43], 7, v45
    ds_read_b128 v[216:219], v3 offset:10496
    s_waitcnt lgkmcnt(6)
    v_mfma_f32_16x16x32_bf16 v[152:155], v[224:227], v[240:243], 0
    ds_read_b128 v[220:223], v3 offset:12288
    s_waitcnt lgkmcnt(6)
    v_mfma_f32_16x16x32_bf16 v[156:159], v[228:231], v[240:243], 0
    ds_read_b128 v[224:227], v3 offset:12544
    s_waitcnt lgkmcnt(6)
    v_mfma_f32_16x16x32_bf16 v[160:163], v[232:235], v[240:243], 0
    ds_read_b128 v[228:231], v3 offset:14336
    s_waitcnt lgkmcnt(6)
    v_mfma_f32_16x16x32_bf16 v[164:167], v[204:207], v[240:243], 0
    ds_read_b128 v[232:235], v3 offset:14592
    s_waitcnt lgkmcnt(6)
    v_mfma_f32_16x16x32_bf16 v[168:171], v[208:211], v[240:243], 0
    ds_read_b128 v[204:207], v3 offset:16384
    s_waitcnt lgkmcnt(6)
    v_mfma_f32_16x16x32_bf16 v[172:175], v[212:215], v[240:243], 0
    ds_read_b128 v[208:211], v3 offset:16640
    s_waitcnt lgkmcnt(6)
    v_mfma_f32_16x16x32_bf16 v[176:179], v[216:219], v[240:243], 0
    s_waitcnt lgkmcnt(5)
    v_mfma_f32_16x16x32_bf16 v[180:183], v[220:223], v[240:243], 0
    s_waitcnt lgkmcnt(4)
    v_mfma_f32_16x16x32_bf16 v[184:187], v[224:227], v[240:243], 0
    s_waitcnt lgkmcnt(3)
    v_mfma_f32_16x16x32_bf16 v[188:191], v[228:231], v[240:243], 0
    s_waitcnt lgkmcnt(2)
    v_mfma_f32_16x16x32_bf16 v[192:195], v[232:235], v[240:243], 0
    s_waitcnt lgkmcnt(1)
    v_mfma_f32_16x16x32_bf16 v[196:199], v[204:207], v[240:243], 0
    s_waitcnt lgkmcnt(0)
    v_mfma_f32_16x16x32_bf16 v[200:203], v[208:211], v[240:243], 0
    s_cmp_ge_u32 s86, 8
    s_nop 6
    s_cbranch_scc1 L_allvalid
    s_cmp_ge_u32 s86, 8
    s_cbranch_scc1 L_allvalid
    v_mov_b32 v132, 0xf149f2ca
    v_mov_b32 v133, 0xf149f2ca
    v_mov_b32 v134, 0xf149f2ca
    v_mov_b32 v135, 0xf149f2ca
    v_mov_b32 v136, 0xf149f2ca
    v_mov_b32 v137, 0xf149f2ca
    v_mov_b32 v138, 0xf149f2ca
    v_mov_b32 v139, 0xf149f2ca
    s_cmp_ge_u32 s86, 7
    s_nop 0
    s_cbranch_scc1 L_allvalid
    v_mov_b32 v140, 0xf149f2ca
    v_mov_b32 v141, 0xf149f2ca
    v_mov_b32 v142, 0xf149f2ca
    v_mov_b32 v143, 0xf149f2ca
    v_mov_b32 v144, 0xf149f2ca
    v_mov_b32 v145, 0xf149f2ca
    v_mov_b32 v146, 0xf149f2ca
    v_mov_b32 v147, 0xf149f2ca
    s_cmp_ge_u32 s86, 6
    s_nop 0
    s_cbranch_scc1 L_allvalid
    v_mov_b32 v148, 0xf149f2ca
    v_mov_b32 v149, 0xf149f2ca
    v_mov_b32 v150, 0xf149f2ca
    v_mov_b32 v151, 0xf149f2ca
    v_mov_b32 v152, 0xf149f2ca
    v_mov_b32 v153, 0xf149f2ca
    v_mov_b32 v154, 0xf149f2ca
    v_mov_b32 v155, 0xf149f2ca
    s_cmp_ge_u32 s86, 5
    s_nop 0
    s_cbranch_scc1 L_allvalid
    v_mov_b32 v156, 0xf149f2ca
    v_mov_b32 v157, 0xf149f2ca
    v_mov_b32 v158, 0xf149f2ca
    v_mov_b32 v159, 0xf149f2ca
    v_mov_b32 v160, 0xf149f2ca
    v_mov_b32 v161, 0xf149f2ca
    v_mov_b32 v162, 0xf149f2ca
    v_mov_b32 v163, 0xf149f2ca
    s_cmp_ge_u32 s86, 4
    s_nop 0
    s_cbranch_scc1 L_allvalid
    v_mov_b32 v164, 0xf149f2ca
    v_mov_b32 v165, 0xf149f2ca
    v_mov_b32 v166, 0xf149f2ca
    v_mov_b32 v167, 0xf149f2ca
    v_mov_b32 v168, 0xf149f2ca
    v_mov_b32 v169, 0xf149f2ca
    v_mov_b32 v170, 0xf149f2ca
    v_mov_b32 v171, 0xf149f2ca
    s_cmp_ge_u32 s86, 3
    s_nop 0
    s_cbranch_scc1 L_allvalid
    v_mov_b32 v172, 0xf149f2ca
    v_mov_b32 v173, 0xf149f2ca
    v_mov_b32 v174, 0xf149f2ca
    v_mov_b32 v175, 0xf149f2ca
    v_mov_b32 v176, 0xf149f2ca
    v_mov_b32 v177, 0xf149f2ca
    v_mov_b32 v178, 0xf149f2ca
    v_mov_b32 v179, 0xf149f2ca
    s_cmp_ge_u32 s86, 2
    s_nop 0
    s_cbranch_scc1 L_allvalid
    v_mov_b32 v180, 0xf149f2ca
    v_mov_b32 v181, 0xf149f2ca
    v_mov_b32 v182, 0xf149f2ca
    v_mov_b32 v183, 0xf149f2ca
    v_mov_b32 v184, 0xf149f2ca
    v_mov_b32 v185, 0xf149f2ca
    v_mov_b32 v186, 0xf149f2ca
    v_mov_b32 v187, 0xf149f2ca
    s_cmp_ge_u32 s86, 1
    s_nop 0
    s_cbranch_scc1 L_allvalid
    v_mov_b32 v188, 0xf149f2ca
    v_mov_b32 v189, 0xf149f2ca
    v_mov_b32 v190, 0xf149f2ca
    v_mov_b32 v191, 0xf149f2ca
    v_mov_b32 v192, 0xf149f2ca
    v_mov_b32 v193, 0xf149f2ca
    v_mov_b32 v194, 0xf149f2ca
    v_mov_b32 v195, 0xf149f2ca
    s_nop 1
L_allvalid:
    v_cndmask_b32 v132, v132, v196, s[24:25]
    v_cndmask_b32 v133, v133, v197, s[26:27]
    v_cndmask_b32 v134, v134, v198, s[16:17]
    v_cndmask_b32 v135, v135, v199, s[64:65]
    v_cndmask_b32 v136, v136, v200, s[32:33]
    v_cndmask_b32 v137, v137, v201, s[34:35]
    v_cndmask_b32 v138, v138, v202, s[40:41]
    v_cndmask_b32 v139, v139, v203, s[42:43]
    v_max3_f32 v2, v140, v141, v142
    v_max3_f32 v128, v143, v144, v145
    v_max3_f32 v2, v2, v146, v147
    v_max3_f32 v128, v128, v148, v149
    s_add_u32 m0, s30, 16384
    s_add_u32 s73, s95, 114688
    s_sub_u32 s0, s73, 1605632
    s_min_u32 s73, s73, s0
    buffer_load_dwordx4 v44, s[52:55], s73 offen lds
    v_max3_f32 v2, v2, v150, v151
    v_max3_f32 v128, v128, v152, v153
    v_max3_f32 v2, v2, v154, v155
    v_max3_f32 v128, v128, v156, v157
    v_max3_f32 v2, v2, v158, v159
    v_max3_f32 v128, v128, v160, v161
    v_max3_f32 v2, v2, v162, v163
    v_max3_f32 v128, v128, v164, v165
    v_max3_f32 v2, v2, v166, v167
    v_max3_f32 v128, v128, v168, v169
    v_max3_f32 v2, v2, v170, v171
    v_max3_f32 v128, v128, v172, v173
    s_add_u32 m0, s30, 17408
    s_add_u32 s73, s95, 121856
    s_sub_u32 s0, s73, 1605632
    s_min_u32 s73, s73, s0
    buffer_load_dwordx4 v44, s[52:55], s73 offen lds
    v_max3_f32 v2, v2, v174, v175
    v_max3_f32 v128, v128, v176, v177
    v_max3_f32 v2, v2, v178, v179
    v_max3_f32 v128, v128, v180, v181
    v_max3_f32 v2, v2, v182, v183
    v_max3_f32 v128, v128, v184, v185
    v_max3_f32 v2, v2, v186, v187
    v_max3_f32 v128, v128, v188, v189
    v_max3_f32 v2, v2, v190, v191
    v_max3_f32 v128, v128, v192, v193
    v_max3_f32 v2, v2, v194, v195
    v_max3_f32 v128, v128, v132, v133
    s_add_u32 m0, s30, 32768
    s_add_u32 s73, s95, 229376
    s_sub_u32 s0, s73, 1605632
    s_min_u32 s73, s73, s0
    buffer_load_dwordx4 v44, s[52:55], s73 offen lds
    v_max3_f32 v2, v2, v134, v135
    v_max3_f32 v128, v128, v136, v137
    v_max3_f32 v2, v2, v138, v139
    v_max_f32 v2, v2, v128
    v_mov_b32 v128, v2
    s_nop 1
    v_permlane32_swap_b32 v2, v128
    v_max_f32 v2, v2, v128
    v_mov_b32 v128, v2
    s_nop 1
    v_permlane16_swap_b32 v2, v128
    v_max_f32 v2, v2, v128
    s_waitcnt vmcnt(3)
    s_barrier
    s_add_u32 s75, s20, 2048
    buffer_store_dwordx2 v[248:249], v252, s[48:51], s75 offen sc1
    v_pk_add_f32 v[140:141], v[140:141], v[2:3] op_sel_hi:[1,0] neg_lo:[0,1] neg_hi:[0,1]
    v_pk_add_f32 v[142:143], v[142:143], v[2:3] op_sel_hi:[1,0] neg_lo:[0,1] neg_hi:[0,1]
    v_pk_add_f32 v[144:145], v[144:145], v[2:3] op_sel_hi:[1,0] neg_lo:[0,1] neg_hi:[0,1]
    v_pk_add_f32 v[146:147], v[146:147], v[2:3] op_sel_hi:[1,0] neg_lo:[0,1] neg_hi:[0,1]
    v_exp_f32 v140, v140
    v_exp_f32 v141, v141
    v_exp_f32 v142, v142
    v_exp_f32 v143, v143
    v_exp_f32 v144, v144
    s_add_u32 m0, s30, 33792
    s_add_u32 s73, s95, 236544
    s_sub_u32 s0, s73, 1605632
    s_min_u32 s73, s73, s0
    buffer_load_dwordx4 v44, s[52:55], s73 offen lds
    v_exp_f32 v145, v145
    v_exp_f32 v146, v146
    v_exp_f32 v147, v147
    v_cvt_pk_bf16_f32 v68, v140, v141
    v_cvt_pk_bf16_f32 v69, v142, v143
    v_cvt_pk_bf16_f32 v70, v144, v145
    v_cvt_pk_bf16_f32 v71, v146, v147
    ds_read_b128 v[204:207], v4 offset:2048
    ds_read_b128 v[208:211], v4 offset:2304
    ds_read_b128 v[212:215], v4 offset:4096
    ds_read_b128 v[216:219], v4 offset:4352
    ds_read_b128 v[220:223], v4 offset:6144
    ds_read_b128 v[224:227], v4 offset:6400
    v_pk_add_f32 v[148:149], v[148:149], v[2:3] op_sel_hi:[1,0] neg_lo:[0,1] neg_hi:[0,1]
    v_pk_add_f32 v[150:151], v[150:151], v[2:3] op_sel_hi:[1,0] neg_lo:[0,1] neg_hi:[0,1]
    v_pk_add_f32 v[152:153], v[152:153], v[2:3] op_sel_hi:[1,0] neg_lo:[0,1] neg_hi:[0,1]
    v_pk_add_f32 v[154:155], v[154:155], v[2:3] op_sel_hi:[1,0] neg_lo:[0,1] neg_hi:[0,1]
    v_exp_f32 v148, v148
    s_add_u32 m0, s30, 49152
    s_add_u32 s73, s95, 344064
    s_sub_u32 s0, s73, 1605632
    s_min_u32 s73, s73, s0
    buffer_load_dwordx4 v44, s[52:55], s73 offen lds
    v_exp_f32 v149, v149
    v_exp_f32 v150, v150
    v_exp_f32 v151, v151
    v_exp_f32 v152, v152
    v_exp_f32 v153, v153
    v_exp_f32 v154, v154
    v_exp_f32 v155, v155
    v_cvt_pk_bf16_f32 v72, v148, v149
    v_cvt_pk_bf16_f32 v73, v150, v151
    v_cvt_pk_bf16_f32 v74, v152, v153
    v_cvt_pk_bf16_f32 v75, v154, v155
    ds_read_b128 v[228:231], v4 offset:8192
    s_waitcnt lgkmcnt(6)
    v_mfma_f32_16x16x32_bf16 v[100:103], v[204:207], v[68:71], 0
    ds_read_b128 v[232:235], v4 offset:8448
    s_waitcnt lgkmcnt(6)
    v_mfma_f32_16x16x32_bf16 v[104:107], v[208:211], v[68:71], 0
    v_pk_add_f32 v[156:157], v[156:157], v[2:3] op_sel_hi:[1,0] neg_lo:[0,1] neg_hi:[0,1]
    s_add_u32 m0, s30, 50176
    s_add_u32 s73, s95, 351232
    s_sub_u32 s0, s73, 1605632
    s_min_u32 s73, s73, s0
    buffer_load_dwordx4 v44, s[52:55], s73 offen lds
    v_pk_add_f32 v[158:159], v[158:159], v[2:3] op_sel_hi:[1,0] neg_lo:[0,1] neg_hi:[0,1]
    v_pk_add_f32 v[160:161], v[160:161], v[2:3] op_sel_hi:[1,0] neg_lo:[0,1] neg_hi:[0,1]
    v_pk_add_f32 v[162:163], v[162:163], v[2:3] op_sel_hi:[1,0] neg_lo:[0,1] neg_hi:[0,1]
    v_exp_f32 v156, v156
    v_exp_f32 v157, v157
    v_exp_f32 v158, v158
    v_exp_f32 v159, v159
    v_exp_f32 v160, v160
    v_exp_f32 v161, v161
    v_exp_f32 v162, v162
    v_exp_f32 v163, v163
    v_cvt_pk_bf16_f32 v76, v156, v157
    s_add_u32 m0, s30, 65536
    s_add_u32 s73, s95, 458752
    s_sub_u32 s0, s73, 1605632
    s_min_u32 s73, s73, s0
    buffer_load_dwordx4 v44, s[52:55], s73 offen lds
    v_cvt_pk_bf16_f32 v77, v158, v159
    v_cvt_pk_bf16_f32 v78, v160, v161
    v_cvt_pk_bf16_f32 v79, v162, v163
    ds_read_b128 v[204:207], v4 offset:10240
    s_waitcnt lgkmcnt(6)
    v_mfma_f32_16x16x32_bf16 v[100:103], v[212:215], v[72:75], v[100:103]
    ds_read_b128 v[208:211], v4 offset:10496
    s_waitcnt lgkmcnt(6)
    v_mfma_f32_16x16x32_bf16 v[104:107], v[216:219], v[72:75], v[104:107]
    v_pk_add_f32 v[164:165], v[164:165], v[2:3] op_sel_hi:[1,0] neg_lo:[0,1] neg_hi:[0,1]
    v_pk_add_f32 v[166:167], v[166:167], v[2:3] op_sel_hi:[1,0] neg_lo:[0,1] neg_hi:[0,1]
    v_pk_add_f32 v[168:169], v[168:169], v[2:3] op_sel_hi:[1,0] neg_lo:[0,1] neg_hi:[0,1]
    v_pk_add_f32 v[170:171], v[170:171], v[2:3] op_sel_hi:[1,0] neg_lo:[0,1] neg_hi:[0,1]
    v_exp_f32 v164, v164
    v_exp_f32 v165, v165
    v_exp_f32 v166, v166
    v_exp_f32 v167, v167
    v_exp_f32 v168, v168
    s_add_u32 m0, s30, 66560
    s_add_u32 s73, s95, 465920
    s_sub_u32 s0, s73, 1605632
    s_min_u32 s73, s73, s0
    buffer_load_dwordx4 v44, s[52:55], s73 offen lds
    v_exp_f32 v169, v169
    v_exp_f32 v170, v170
    v_exp_f32 v171, v171
    v_cvt_pk_bf16_f32 v80, v164, v165
    v_cvt_pk_bf16_f32 v81, v166, v167
    v_cvt_pk_bf16_f32 v82, v168, v169
    v_cvt_pk_bf16_f32 v83, v170, v171
    ds_read_b128 v[212:215], v4 offset:12288
    s_waitcnt lgkmcnt(6)
    v_mfma_f32_16x16x32_bf16 v[100:103], v[220:223], v[76:79], v[100:103]
    ds_read_b128 v[216:219], v4 offset:12544
    s_waitcnt lgkmcnt(6)
    v_mfma_f32_16x16x32_bf16 v[104:107], v[224:227], v[76:79], v[104:107]
    buffer_load_dwordx2 v[254:255], v46, s[48:51], 0 offen sc1
    v_pk_add_f32 v[172:173], v[172:173], v[2:3] op_sel_hi:[1,0] neg_lo:[0,1] neg_hi:[0,1]
    v_pk_add_f32 v[174:175], v[174:175], v[2:3] op_sel_hi:[1,0] neg_lo:[0,1] neg_hi:[0,1]
    v_pk_add_f32 v[176:177], v[176:177], v[2:3] op_sel_hi:[1,0] neg_lo:[0,1] neg_hi:[0,1]
    v_pk_add_f32 v[178:179], v[178:179], v[2:3] op_sel_hi:[1,0] neg_lo:[0,1] neg_hi:[0,1]
    v_exp_f32 v172, v172
    v_exp_f32 v173, v173
    v_exp_f32 v174, v174
    v_exp_f32 v175, v175
    v_exp_f32 v176, v176
    v_exp_f32 v177, v177
    v_exp_f32 v178, v178
    v_exp_f32 v179, v179
    v_cvt_pk_bf16_f32 v84, v172, v173
    v_cvt_pk_bf16_f32 v85, v174, v175
    v_cvt_pk_bf16_f32 v86, v176, v177
    v_cvt_pk_bf16_f32 v87, v178, v179
    ds_read_b128 v[220:223], v4 offset:14336
    s_waitcnt lgkmcnt(6)
    v_mfma_f32_16x16x32_bf16 v[100:103], v[228:231], v[80:83], v[100:103]
    ds_read_b128 v[224:227], v4 offset:14592
    s_waitcnt lgkmcnt(6)
    v_mfma_f32_16x16x32_bf16 v[104:107], v[232:235], v[80:83], v[104:107]
    v_pk_add_f32 v[180:181], v[180:181], v[2:3] op_sel_hi:[1,0] neg_lo:[0,1] neg_hi:[0,1]
    v_pk_add_f32 v[182:183], v[182:183], v[2:3] op_sel_hi:[1,0] neg_lo:[0,1] neg_hi:[0,1]
    v_pk_add_f32 v[184:185], v[184:185], v[2:3] op_sel_hi:[1,0] neg_lo:[0,1] neg_hi:[0,1]
    v_pk_add_f32 v[186:187], v[186:187], v[2:3] op_sel_hi:[1,0] neg_lo:[0,1] neg_hi:[0,1]
    v_exp_f32 v180, v180
    v_exp_f32 v181, v181
    v_exp_f32 v182, v182
    v_exp_f32 v183, v183
    v_exp_f32 v184, v184
    v_exp_f32 v185, v185
    v_exp_f32 v186, v186
    v_exp_f32 v187, v187
    v_cvt_pk_bf16_f32 v88, v180, v181
    v_cvt_pk_bf16_f32 v89, v182, v183
    v_cvt_pk_bf16_f32 v90, v184, v185
    v_cvt_pk_bf16_f32 v91, v186, v187
    ds_read_b128 v[228:231], v4 offset:0
    s_waitcnt lgkmcnt(6)
    v_mfma_f32_16x16x32_bf16 v[100:103], v[204:207], v[84:87], v[100:103]
    ds_read_b128 v[232:235], v4 offset:256
    s_waitcnt lgkmcnt(6)
    v_mfma_f32_16x16x32_bf16 v[104:107], v[208:211], v[84:87], v[104:107]
    v_pk_add_f32 v[188:189], v[188:189], v[2:3] op_sel_hi:[1,0] neg_lo:[0,1] neg_hi:[0,1]
    v_pk_add_f32 v[190:191], v[190:191], v[2:3] op_sel_hi:[1,0] neg_lo:[0,1] neg_hi:[0,1]
    v_pk_add_f32 v[192:193], v[192:193], v[2:3] op_sel_hi:[1,0] neg_lo:[0,1] neg_hi:[0,1]
    v_pk_add_f32 v[194:195], v[194:195], v[2:3] op_sel_hi:[1,0] neg_lo:[0,1] neg_hi:[0,1]
    v_exp_f32 v188, v188
    v_exp_f32 v189, v189
    v_exp_f32 v190, v190
    v_exp_f32 v191, v191
    v_exp_f32 v192, v192
    v_exp_f32 v193, v193
    v_exp_f32 v194, v194
    v_exp_f32 v195, v195
    v_cvt_pk_bf16_f32 v92, v188, v189
    v_cvt_pk_bf16_f32 v93, v190, v191
    v_cvt_pk_bf16_f32 v94, v192, v193
    v_cvt_pk_bf16_f32 v95, v194, v195
    s_cmp_ge_u32 s89, 7
    s_nop 0
    s_cbranch_scc1 L_noC0
    s_cmp_lg_u32 s68, 0
    s_cbranch_scc1 L_wf_done6
    s_mov_b32 s76, 0
    s_waitcnt vmcnt(0)
L_wf6:
    v_cmp_eq_u64 vcc, v[254:255], v[248:249]
    s_nop 0
    s_and_b32 s75, vcc_lo, 65535
    s_cmp_eq_u32 s75, 65535
    s_nop 1
    s_cbranch_scc1 L_wf_done6
    s_add_u32 s76, s76, 1
    s_cmp_gt_u32 s76, 100000
    s_cbranch_scc1 L_wf_done6
    s_sleep 4
    buffer_load_dwordx2 v[254:255], v46, s[48:51], 0 offen sc1
    s_waitcnt vmcnt(0)
    s_branch L_wf6
L_wf_done6:
    s_barrier
    s_add_u32 m0, s29, 0
    s_add_u32 s73, s94, 0
    s_sub_u32 s0, s73, 114688
    s_min_u32 s73, s73, s0
    s_add_u32 s73, s73, s93
    buffer_load_dwordx4 v6, s[48:51], s73 offen offset:0 sc1 lds
    buffer_load_dwordx4 v6, s[48:51], s73 offen offset:1024 sc1 lds
    s_add_u32 m0, s29, 49152
    s_add_u32 s73, s94, 8192
    s_sub_u32 s0, s73, 114688
    s_min_u32 s73, s73, s0
    s_add_u32 s73, s73, s93
    buffer_load_dwordx4 v6, s[48:51], s73 offen offset:0 sc1 lds
    buffer_load_dwordx4 v6, s[48:51], s73 offen offset:1024 sc1 lds
L_noC0:
    ds_read_b128 v[204:207], v4 offset:16384
    s_waitcnt lgkmcnt(6)
    v_mfma_f32_16x16x32_bf16 v[100:103], v[212:215], v[88:91], v[100:103]
    ds_read_b128 v[208:211], v4 offset:16640
    s_waitcnt lgkmcnt(6)
    v_mfma_f32_16x16x32_bf16 v[104:107], v[216:219], v[88:91], v[104:107]
    v_pk_add_f32 v[132:133], v[132:133], v[2:3] op_sel_hi:[1,0] neg_lo:[0,1] neg_hi:[0,1]
    v_pk_add_f32 v[134:135], v[134:135], v[2:3] op_sel_hi:[1,0] neg_lo:[0,1] neg_hi:[0,1]
    v_pk_add_f32 v[136:137], v[136:137], v[2:3] op_sel_hi:[1,0] neg_lo:[0,1] neg_hi:[0,1]
    v_pk_add_f32 v[138:139], v[138:139], v[2:3] op_sel_hi:[1,0] neg_lo:[0,1] neg_hi:[0,1]
    v_exp_f32 v132, v132
    v_exp_f32 v133, v133
    v_exp_f32 v134, v134
    v_exp_f32 v135, v135
    v_exp_f32 v136, v136
    v_exp_f32 v137, v137
    v_exp_f32 v138, v138
    v_exp_f32 v139, v139
    v_cndmask_b32 v196, 0, v132, s[24:25]
    v_cndmask_b32 v197, 0, v133, s[26:27]
    v_cndmask_b32 v198, 0, v134, s[16:17]
    v_cndmask_b32 v199, 0, v135, s[64:65]
    v_cndmask_b32 v200, 0, v136, s[32:33]
    v_cndmask_b32 v201, 0, v137, s[34:35]
    v_cndmask_b32 v202, 0, v138, s[40:41]
    v_cndmask_b32 v203, 0, v139, s[42:43]
    v_cndmask_b32 v132, v132, 0, s[24:25]
    v_cndmask_b32 v133, v133, 0, s[26:27]
    v_cndmask_b32 v134, v134, 0, s[16:17]
    v_cndmask_b32 v135, v135, 0, s[64:65]
    v_cndmask_b32 v136, v136, 0, s[32:33]
    v_cndmask_b32 v137, v137, 0, s[34:35]
    v_cndmask_b32 v138, v138, 0, s[40:41]
    v_cndmask_b32 v139, v139, 0, s[42:43]
    v_cvt_pk_bf16_f32 v96, v196, v197
    v_cvt_pk_bf16_f32 v97, v198, v199
    v_cvt_pk_bf16_f32 v98, v200, v201
    v_cvt_pk_bf16_f32 v99, v202, v203
    v_cvt_pk_bf16_f32 v64, v132, v133
    v_cvt_pk_bf16_f32 v65, v134, v135
    v_cvt_pk_bf16_f32 v66, v136, v137
    v_cvt_pk_bf16_f32 v67, v138, v139
    s_waitcnt lgkmcnt(0)
    s_cmp_ge_u32 s89, 7
    s_cbranch_scc1 L_noC1
    s_barrier
    s_add_u32 m0, s29, 16384
    s_add_u32 s73, s94, 16384
    s_sub_u32 s0, s73, 114688
    s_min_u32 s73, s73, s0
    s_add_u32 s73, s73, s93
    buffer_load_dwordx4 v6, s[48:51], s73 offen offset:0 sc1 lds
    buffer_load_dwordx4 v6, s[48:51], s73 offen offset:1024 sc1 lds
    s_add_u32 m0, s29, 32768
    s_add_u32 s73, s94, 24576
    s_sub_u32 s0, s73, 114688
    s_min_u32 s73, s73, s0
    s_add_u32 s73, s73, s93
    buffer_load_dwordx4 v6, s[48:51], s73 offen offset:0 sc1 lds
    buffer_load_dwordx4 v6, s[48:51], s73 offen offset:1024 sc1 lds
L_noC1:
    v_mfma_f32_16x16x32_bf16 v[100:103], v[220:223], v[92:95], v[100:103]
    v_mfma_f32_16x16x32_bf16 v[104:107], v[224:227], v[92:95], v[104:107]
    v_mfma_f32_16x16x32_bf16 v[100:103], v[228:231], v[64:67], v[100:103]
    v_mfma_f32_16x16x32_bf16 v[104:107], v[232:235], v[64:67], v[104:107]
    v_mfma_f32_16x16x32_bf16 v[100:103], v[204:207], v[96:99], v[100:103]
    v_mfma_f32_16x16x32_bf16 v[104:107], v[208:211], v[96:99], v[104:107]
    s_nop 7
    v_mov_b32 v128, v104
    v_mov_b32 v129, v104
    s_nop 1
    v_permlane32_swap_b32 v128, v129
    v_mov_b32 v128, v129
    s_nop 1
    v_permlane16_swap_b32 v128, v129
    v_rcp_f32 v129, v129
    s_nop 0
    v_mul_f32 v100, v100, v129
    v_mul_f32 v101, v101, v129
    v_mul_f32 v102, v102, v129
    v_mul_f32 v103, v103, v129
    v_mul_f32 v104, v104, v129
    v_mul_f32 v105, v105, v129
    v_mul_f32 v106, v106, v129
    v_mul_f32 v107, v107, v129
    v_cvt_pk_bf16_f32 v240, v100, v101
    v_cvt_pk_bf16_f32 v241, v102, v103
    v_cvt_pk_bf16_f32 v242, v104, v105
    v_cvt_pk_bf16_f32 v243, v106, v107
    v_cmp_gt_u32 s[96:97], 48, v1
    s_nop 1
    v_cndmask_b32 v242, 0, v242, s[96:97]
    v_cndmask_b32 v243, 0, v243, s[96:97]
    buffer_store_dwordx4 v[240:243], v244, s[48:51], s87 offen sc1
    s_cmp_lt_u32 s89, 7
    s_nop 0
    s_cbranch_scc1 L_phaseC
    v_mul_u32_u24 v128, 896, v1
    s_cmp_lt_u32 s68, 7
    s_cselect_b32 s96, -1, 0
    s_mov_b32 s97, 0
    v_cndmask_b32 v128, v250, v128, s[96:97]
    s_and_b32 s75, s88, 3
    s_lshl_b32 s74, s68, 2
    s_lshr_b32 s74, 0x0, s74
    s_and_b32 s74, s74, 15
    s_mul_i32 s74, s74, 896
    s_add_u32 s74, s74, s68
    s_lshl_b32 s74, s74, 7
    s_mul_i32 s76, s75, 28672
    s_add_u32 s74, s74, s76
    s_mul_i32 s76, s75, 25088
    s_lshl_b32 s75, s68, 7
    s_add_u32 s76, s76, s75
    s_add_u32 s73, s74, 917504
    s_sub_u32 s0, s73, 1605632
    s_min_u32 s73, s73, s0
    buffer_load_dword v247, v128, s[52:55], s73 offen
    s_waitcnt vmcnt(1)
    s_barrier
    s_add_u32 s75, s80, 4096
    buffer_store_dwordx2 v[248:249], v252, s[48:51], s75 offen sc1
    s_add_u32 s73, s74, 1032192
    s_sub_u32 s0, s73, 1605632
    s_min_u32 s73, s73, s0
    buffer_load_dword v247, v128, s[52:55], s73 offen
    s_add_u32 s73, s74, 1146880
    s_sub_u32 s0, s73, 1605632
    s_min_u32 s73, s73, s0
    buffer_load_dword v247, v128, s[52:55], s73 offen
    s_add_u32 s73, s74, 1261568
    s_sub_u32 s0, s73, 1605632
    s_min_u32 s73, s73, s0
    buffer_load_dword v247, v128, s[52:55], s73 offen
    s_add_u32 s73, s74, 1376256
    s_sub_u32 s0, s73, 1605632
    s_min_u32 s73, s73, s0
    buffer_load_dword v247, v128, s[52:55], s73 offen
    s_add_u32 s73, s74, 1490944
    s_sub_u32 s0, s73, 1605632
    s_min_u32 s73, s73, s0
    buffer_load_dword v247, v128, s[52:55], s73 offen
    s_add_u32 s73, s76, 0
    buffer_load_dword v247, v128, s[56:59], s73 offen
    s_add_u32 s73, s76, 100352
    buffer_load_dword v247, v128, s[56:59], s73 offen
    s_add_u32 s73, s76, 200704
    buffer_load_dword v247, v128, s[56:59], s73 offen
    s_add_u32 s73, s76, 301056
    buffer_load_dword v247, v128, s[56:59], s73 offen
    s_branch L_end
L_phaseC:
    v_add_u32 v46, 2048, v46
    v_lshrrev_b32 v21, 5, v1
    s_lshl_b32 s74, s91, 13
    s_lshl_b32 s75, s90, 12
    s_add_u32 s74, s74, s75
    v_add_u32 v2, s74, v6
    v_bfe_u32 v20, v1, 2, 2
    v_and_b32 v22, 3, v1
    v_bfe_u32 v23, v1, 4, 1
    v_lshrrev_b32 v24, 1, v22
    v_and_b32 v25, 1, v22
    v_lshl_or_b32 v24, v25, 1, v24
    v_lshl_add_u32 v25, v21, 3, v20
    v_lshlrev_b32 v25, 7, v25
    v_lshrrev_b32 v26, 1, v20
    v_xor_b32 v26, s92, v26
    v_lshl_add_u32 v25, v26, 6, v25
    v_lshl_add_u32 v25, v23, 5, v25
    v_lshl_add_u32 v25, v24, 3, v25
    s_lshl_b32 s74, s90, 13
    s_add_u32 s74, s74, 65536
    v_add_u32 v3, s74, v25
    v_add_u32 v5, 65536, v3
    v_add_u32 v7, 65536, v2
    s_waitcnt vmcnt(7)
    s_barrier
    ds_read_b128 v[64:67], v2 offset:0
    ds_read_b64_tr_b16 v[68:69], v3 offset:0
    ds_read_b64_tr_b16 v[70:71], v3 offset:512
    ds_read_b128 v[72:75], v2 offset:1024
    ds_read_b64_tr_b16 v[76:77], v3 offset:2048
    ds_read_b64_tr_b16 v[78:79], v3 offset:2560
    ds_read_b128 v[80:83], v2 offset:2048
    ds_read_b64_tr_b16 v[84:85], v3 offset:4096
    ds_read_b64_tr_b16 v[86:87], v3 offset:4608
    ds_read_b128 v[88:91], v2 offset:3072
    ds_read_b64_tr_b16 v[92:93], v3 offset:6144
    ds_read_b64_tr_b16 v[94:95], v3 offset:6656
    s_waitcnt vmcnt(5) lgkmcnt(0)
    s_barrier
    s_add_u32 m0, s29, 0
    s_add_u32 s73, s94, 32768
    s_sub_u32 s0, s73, 114688
    s_min_u32 s73, s73, s0
    s_add_u32 s73, s73, s93
    buffer_load_dwordx4 v6, s[48:51], s73 offen offset:0 sc1 lds
    buffer_load_dwordx4 v6, s[48:51], s73 offen offset:1024 sc1 lds
    v_mfma_f32_32x32x16_bf16 v[48:63], v[68:71], v[64:67], 0
    ds_read_b128 v[96:99], v2 offset:49152
    ds_read_b64_tr_b16 v[100:101], v3 offset:16384
    ds_read_b64_tr_b16 v[102:103], v3 offset:16896
    ds_read_b128 v[104:107], v2 offset:50176
    ds_read_b64_tr_b16 v[108:109], v3 offset:18432
    ds_read_b64_tr_b16 v[110:111], v3 offset:18944
    ds_read_b128 v[112:115], v2 offset:51200
    ds_read_b64_tr_b16 v[116:117], v3 offset:20480
    ds_read_b64_tr_b16 v[118:119], v3 offset:20992
    ds_read_b128 v[120:123], v2 offset:52224
    ds_read_b64_tr_b16 v[124:125], v3 offset:22528
    ds_read_b64_tr_b16 v[126:127], v3 offset:23040
    v_mfma_f32_32x32x16_bf16 v[48:63], v[76:79], v[72:75], v[48:63]
    s_add_u32 m0, s30, 0
    s_add_u32 s73, s95, 688128
    s_sub_u32 s0, s73, 1605632
    s_min_u32 s73, s73, s0
    buffer_load_dwordx4 v44, s[52:55], s73 offen lds
    v_mfma_f32_32x32x16_bf16 v[48:63], v[84:87], v[80:83], v[48:63]
    s_add_u32 m0, s30, 1024
    s_add_u32 s73, s95, 695296
    s_sub_u32 s0, s73, 1605632
    s_min_u32 s73, s73, s0
    buffer_load_dwordx4 v44, s[52:55], s73 offen lds
    v_mfma_f32_32x32x16_bf16 v[48:63], v[92:95], v[88:91], v[48:63]
    s_waitcnt vmcnt(4) lgkmcnt(0)
    s_barrier
    s_add_u32 s75, s80, 4096
    buffer_store_dwordx2 v[248:249], v252, s[48:51], s75 offen sc1
    s_add_u32 m0, s29, 49152
    s_add_u32 s73, s94, 40960
    s_sub_u32 s0, s73, 114688
    s_min_u32 s73, s73, s0
    s_add_u32 s73, s73, s93
    buffer_load_dwordx4 v6, s[48:51], s73 offen offset:0 sc1 lds
    buffer_load_dwordx4 v6, s[48:51], s73 offen offset:1024 sc1 lds
    v_mfma_f32_32x32x16_bf16 v[48:63], v[100:103], v[96:99], v[48:63]
    ds_read_b128 v[64:67], v2 offset:16384
    ds_read_b64_tr_b16 v[68:69], v3 offset:32768
    ds_read_b64_tr_b16 v[70:71], v3 offset:33280
    ds_read_b128 v[72:75], v2 offset:17408
    ds_read_b64_tr_b16 v[76:77], v3 offset:34816
    ds_read_b64_tr_b16 v[78:79], v3 offset:35328
    ds_read_b128 v[80:83], v2 offset:18432
    ds_read_b64_tr_b16 v[84:85], v3 offset:36864
    ds_read_b64_tr_b16 v[86:87], v3 offset:37376
    ds_read_b128 v[88:91], v2 offset:19456
    ds_read_b64_tr_b16 v[92:93], v3 offset:38912
    ds_read_b64_tr_b16 v[94:95], v3 offset:39424
    v_mfma_f32_32x32x16_bf16 v[48:63], v[108:111], v[104:107], v[48:63]
    s_add_u32 m0, s30, 16384
    s_add_u32 s73, s95, 802816
    s_sub_u32 s0, s73, 1605632
    s_min_u32 s73, s73, s0
    buffer_load_dwordx4 v44, s[52:55], s73 offen lds
    v_mfma_f32_32x32x16_bf16 v[48:63], v[116:119], v[112:115], v[48:63]
    s_add_u32 m0, s30, 17408
    s_add_u32 s73, s95, 809984
    s_sub_u32 s0, s73, 1605632
    s_min_u32 s73, s73, s0
    buffer_load_dwordx4 v44, s[52:55], s73 offen lds
    v_mfma_f32_32x32x16_bf16 v[48:63], v[124:127], v[120:123], v[48:63]
    s_waitcnt vmcnt(10) lgkmcnt(0)
    s_barrier
    s_add_u32 m0, s29, 16384
    s_add_u32 s73, s94, 49152
    s_sub_u32 s0, s73, 114688
    s_min_u32 s73, s73, s0
    s_add_u32 s73, s73, s93
    buffer_load_dwordx4 v6, s[48:51], s73 offen offset:0 sc1 lds
    buffer_load_dwordx4 v6, s[48:51], s73 offen offset:1024 sc1 lds
    v_mfma_f32_32x32x16_bf16 v[48:63], v[68:71], v[64:67], v[48:63]
    ds_read_b128 v[96:99], v2 offset:32768
    ds_read_b64_tr_b16 v[100:101], v3 offset:49152
    ds_read_b64_tr_b16 v[102:103], v3 offset:49664
    ds_read_b128 v[104:107], v2 offset:33792
    ds_read_b64_tr_b16 v[108:109], v3 offset:51200
    ds_read_b64_tr_b16 v[110:111], v3 offset:51712
    ds_read_b128 v[112:115], v2 offset:34816
    ds_read_b64_tr_b16 v[116:117], v3 offset:53248
    ds_read_b64_tr_b16 v[118:119], v3 offset:53760
    ds_read_b128 v[120:123], v2 offset:35840
    ds_read_b64_tr_b16 v[124:125], v3 offset:55296
    ds_read_b64_tr_b16 v[126:127], v3 offset:55808
    v_mfma_f32_32x32x16_bf16 v[48:63], v[76:79], v[72:75], v[48:63]
    s_add_u32 m0, s30, 32768
    s_add_u32 s73, s95, 917504
    s_sub_u32 s0, s73, 1605632
    s_min_u32 s73, s73, s0
    buffer_load_dwordx4 v44, s[52:55], s73 offen lds
    v_mfma_f32_32x32x16_bf16 v[48:63], v[84:87], v[80:83], v[48:63]
    s_add_u32 m0, s30, 33792
    s_add_u32 s73, s95, 924672
    s_sub_u32 s0, s73, 1605632
    s_min_u32 s73, s73, s0
    buffer_load_dwordx4 v44, s[52:55], s73 offen lds
    v_mfma_f32_32x32x16_bf16 v[48:63], v[92:95], v[88:91], v[48:63]
    s_waitcnt vmcnt(11) lgkmcnt(0)
    s_barrier
    s_add_u32 m0, s29, 32768
    s_add_u32 s73, s94, 57344
    s_sub_u32 s0, s73, 114688
    s_min_u32 s73, s73, s0
    s_add_u32 s73, s73, s93
    buffer_load_dwordx4 v6, s[48:51], s73 offen offset:0 sc1 lds
    buffer_load_dwordx4 v6, s[48:51], s73 offen offset:1024 sc1 lds
    v_mfma_f32_32x32x16_bf16 v[48:63], v[100:103], v[96:99], v[48:63]
    ds_read_b128 v[64:67], v2 offset:0
    ds_read_b64_tr_b16 v[68:69], v5 offset:0
    ds_read_b64_tr_b16 v[70:71], v5 offset:512
    ds_read_b128 v[72:75], v2 offset:1024
    ds_read_b64_tr_b16 v[76:77], v5 offset:2048
    ds_read_b64_tr_b16 v[78:79], v5 offset:2560
    ds_read_b128 v[80:83], v2 offset:2048
    ds_read_b64_tr_b16 v[84:85], v5 offset:4096
    ds_read_b64_tr_b16 v[86:87], v5 offset:4608
    ds_read_b128 v[88:91], v2 offset:3072
    ds_read_b64_tr_b16 v[92:93], v5 offset:6144
    ds_read_b64_tr_b16 v[94:95], v5 offset:6656
    v_mfma_f32_32x32x16_bf16 v[48:63], v[108:111], v[104:107], v[48:63]
    s_add_u32 m0, s30, 49152
    s_add_u32 s73, s95, 1032192
    s_sub_u32 s0, s73, 1605632
    s_min_u32 s73, s73, s0
    buffer_load_dwordx4 v44, s[52:55], s73 offen lds
    v_mfma_f32_32x32x16_bf16 v[48:63], v[116:119], v[112:115], v[48:63]
    v_mfma_f32_32x32x16_bf16 v[48:63], v[124:127], v[120:123], v[48:63]
    s_waitcnt vmcnt(9) lgkmcnt(0)
    s_barrier
    s_add_u32 m0, s29, 0
    s_add_u32 s73, s94, 65536
    s_sub_u32 s0, s73, 114688
    s_min_u32 s73, s73, s0
    s_add_u32 s73, s73, s93
    buffer_load_dwordx4 v6, s[48:51], s73 offen offset:0 sc1 lds
    buffer_load_dwordx4 v6, s[48:51], s73 offen offset:1024 sc1 lds
    v_mfma_f32_32x32x16_bf16 v[48:63], v[68:71], v[64:67], v[48:63]
    ds_read_b128 v[96:99], v2 offset:49152
    ds_read_b64_tr_b16 v[100:101], v5 offset:16384
    ds_read_b64_tr_b16 v[102:103], v5 offset:16896
    ds_read_b128 v[104:107], v2 offset:50176
    ds_read_b64_tr_b16 v[108:109], v5 offset:18432
    ds_read_b64_tr_b16 v[110:111], v5 offset:18944
    ds_read_b128 v[112:115], v2 offset:51200
    ds_read_b64_tr_b16 v[116:117], v5 offset:20480
    ds_read_b64_tr_b16 v[118:119], v5 offset:20992
    ds_read_b128 v[120:123], v2 offset:52224
    ds_read_b64_tr_b16 v[124:125], v5 offset:22528
    ds_read_b64_tr_b16 v[126:127], v5 offset:23040
    v_mfma_f32_32x32x16_bf16 v[48:63], v[76:79], v[72:75], v[48:63]
    s_add_u32 m0, s30, 50176
    s_add_u32 s73, s95, 1039360
    s_sub_u32 s0, s73, 1605632
    s_min_u32 s73, s73, s0
    buffer_load_dwordx4 v44, s[52:55], s73 offen lds
    v_mfma_f32_32x32x16_bf16 v[48:63], v[84:87], v[80:83], v[48:63]
    s_add_u32 m0, s30, 65536
    s_add_u32 s73, s95, 1146880
    s_sub_u32 s0, s73, 1605632
    s_min_u32 s73, s73, s0
    buffer_load_dwordx4 v44, s[52:55], s73 offen lds
    v_mfma_f32_32x32x16_bf16 v[48:63], v[92:95], v[88:91], v[48:63]
    s_waitcnt vmcnt(9) lgkmcnt(0)
    s_barrier
    s_add_u32 m0, s29, 49152
    s_add_u32 s73, s94, 73728
    s_sub_u32 s0, s73, 114688
    s_min_u32 s73, s73, s0
    s_add_u32 s73, s73, s93
    buffer_load_dwordx4 v6, s[48:51], s73 offen offset:0 sc1 lds
    buffer_load_dwordx4 v6, s[48:51], s73 offen offset:1024 sc1 lds
    v_mfma_f32_32x32x16_bf16 v[48:63], v[100:103], v[96:99], v[48:63]
    ds_read_b128 v[64:67], v2 offset:16384
    ds_read_b64_tr_b16 v[68:69], v3 offset:0
    ds_read_b64_tr_b16 v[70:71], v3 offset:512
    ds_read_b128 v[72:75], v2 offset:17408
    ds_read_b64_tr_b16 v[76:77], v3 offset:2048
    ds_read_b64_tr_b16 v[78:79], v3 offset:2560
    ds_read_b128 v[80:83], v2 offset:18432
    ds_read_b64_tr_b16 v[84:85], v3 offset:4096
    ds_read_b64_tr_b16 v[86:87], v3 offset:4608
    ds_read_b128 v[88:91], v2 offset:19456
    ds_read_b64_tr_b16 v[92:93], v3 offset:6144
    ds_read_b64_tr_b16 v[94:95], v3 offset:6656
    v_mfma_f32_32x32x16_bf16 v[48:63], v[108:111], v[104:107], v[48:63]
    s_add_u32 m0, s30, 66560
    s_add_u32 s73, s95, 1154048
    s_sub_u32 s0, s73, 1605632
    s_min_u32 s73, s73, s0
    buffer_load_dwordx4 v44, s[52:55], s73 offen lds
    v_mfma_f32_32x32x16_bf16 v[48:63], v[116:119], v[112:115], v[48:63]
    s_add_u32 m0, s30, 81920
    s_add_u32 s73, s95, 1261568
    s_sub_u32 s0, s73, 1605632
    s_min_u32 s73, s73, s0
    buffer_load_dwordx4 v44, s[52:55], s73 offen lds
    v_mfma_f32_32x32x16_bf16 v[48:63], v[124:127], v[120:123], v[48:63]
    s_waitcnt vmcnt(9) lgkmcnt(0)
    s_barrier
    s_add_u32 m0, s29, 16384
    s_add_u32 s73, s94, 81920
    s_sub_u32 s0, s73, 114688
    s_min_u32 s73, s73, s0
    s_add_u32 s73, s73, s93
    buffer_load_dwordx4 v6, s[48:51], s73 offen offset:0 sc1 lds
    buffer_load_dwordx4 v6, s[48:51], s73 offen offset:1024 sc1 lds
    v_mfma_f32_32x32x16_bf16 v[48:63], v[68:71], v[64:67], v[48:63]
    ds_read_b128 v[96:99], v2 offset:32768
    ds_read_b64_tr_b16 v[100:101], v3 offset:16384
    ds_read_b64_tr_b16 v[102:103], v3 offset:16896
    ds_read_b128 v[104:107], v2 offset:33792
    ds_read_b64_tr_b16 v[108:109], v3 offset:18432
    ds_read_b64_tr_b16 v[110:111], v3 offset:18944
    ds_read_b128 v[112:115], v2 offset:34816
    ds_read_b64_tr_b16 v[116:117], v3 offset:20480
    ds_read_b64_tr_b16 v[118:119], v3 offset:20992
    ds_read_b128 v[120:123], v2 offset:35840
    ds_read_b64_tr_b16 v[124:125], v3 offset:22528
    ds_read_b64_tr_b16 v[126:127], v3 offset:23040
    v_mfma_f32_32x32x16_bf16 v[48:63], v[76:79], v[72:75], v[48:63]
    s_add_u32 m0, s30, 82944
    s_add_u32 s73, s95, 1268736
    s_sub_u32 s0, s73, 1605632
    s_min_u32 s73, s73, s0
    buffer_load_dwordx4 v44, s[52:55], s73 offen lds
    v_mfma_f32_32x32x16_bf16 v[48:63], v[84:87], v[80:83], v[48:63]
    v_mfma_f32_32x32x16_bf16 v[48:63], v[92:95], v[88:91], v[48:63]
    s_waitcnt vmcnt(9) lgkmcnt(0)
    s_barrier
    buffer_load_dwordx2 v[254:255], v46, s[48:51], 0 offen sc1
    v_mfma_f32_32x32x16_bf16 v[48:63], v[100:103], v[96:99], v[48:63]
    ds_read_b128 v[64:67], v2 offset:0
    ds_read_b64_tr_b16 v[68:69], v3 offset:32768
    ds_read_b64_tr_b16 v[70:71], v3 offset:33280
    ds_read_b128 v[72:75], v2 offset:1024
    ds_read_b64_tr_b16 v[76:77], v3 offset:34816
    ds_read_b64_tr_b16 v[78:79], v3 offset:35328
    ds_read_b128 v[80:83], v2 offset:2048
    ds_read_b64_tr_b16 v[84:85], v3 offset:36864
    ds_read_b64_tr_b16 v[86:87], v3 offset:37376
    ds_read_b128 v[88:91], v2 offset:3072
    ds_read_b64_tr_b16 v[92:93], v3 offset:38912
    ds_read_b64_tr_b16 v[94:95], v3 offset:39424
    v_mfma_f32_32x32x16_bf16 v[48:63], v[108:111], v[104:107], v[48:63]
    s_add_u32 m0, s29, 32768
    s_add_u32 s73, s94, 90112
    s_sub_u32 s0, s73, 114688
    s_min_u32 s73, s73, s0
    s_add_u32 s73, s73, s93
    buffer_load_dwordx4 v6, s[48:51], s73 offen offset:0 sc1 lds
    buffer_load_dwordx4 v6, s[48:51], s73 offen offset:1024 sc1 lds
    v_mfma_f32_32x32x16_bf16 v[48:63], v[116:119], v[112:115], v[48:63]
    s_add_u32 m0, s30, 0
    s_add_u32 s73, s95, 1376256
    s_sub_u32 s0, s73, 1605632
    s_min_u32 s73, s73, s0
    buffer_load_dwordx4 v44, s[52:55], s73 offen lds
    v_mfma_f32_32x32x16_bf16 v[48:63], v[124:127], v[120:123], v[48:63]
    s_add_u32 m0, s30, 1024
    s_add_u32 s73, s95, 1383424
    s_sub_u32 s0, s73, 1605632
    s_min_u32 s73, s73, s0
    buffer_load_dwordx4 v44, s[52:55], s73 offen lds
    s_waitcnt vmcnt(10) lgkmcnt(0)
    s_barrier
    s_add_u32 m0, s29, 0
    s_add_u32 s73, s94, 98304
    s_sub_u32 s0, s73, 114688
    s_min_u32 s73, s73, s0
    s_add_u32 s73, s73, s93
    buffer_load_dwordx4 v6, s[48:51], s73 offen offset:0 sc1 lds
    buffer_load_dwordx4 v6, s[48:51], s73 offen offset:1024 sc1 lds
    v_mfma_f32_32x32x16_bf16 v[48:63], v[68:71], v[64:67], v[48:63]
    ds_read_b128 v[96:99], v2 offset:49152
    ds_read_b64_tr_b16 v[100:101], v3 offset:49152
    ds_read_b64_tr_b16 v[102:103], v3 offset:49664
    ds_read_b128 v[104:107], v2 offset:50176
    ds_read_b64_tr_b16 v[108:109], v3 offset:51200
    ds_read_b64_tr_b16 v[110:111], v3 offset:51712
    ds_read_b128 v[112:115], v2 offset:51200
    ds_read_b64_tr_b16 v[116:117], v3 offset:53248
    ds_read_b64_tr_b16 v[118:119], v3 offset:53760
    ds_read_b128 v[120:123], v2 offset:52224
    ds_read_b64_tr_b16 v[124:125], v3 offset:55296
    ds_read_b64_tr_b16 v[126:127], v3 offset:55808
    v_mfma_f32_32x32x16_bf16 v[48:63], v[76:79], v[72:75], v[48:63]
    s_add_u32 m0, s30, 16384
    s_add_u32 s73, s95, 1490944
    s_sub_u32 s0, s73, 1605632
    s_min_u32 s73, s73, s0
    buffer_load_dwordx4 v44, s[52:55], s73 offen lds
    v_mfma_f32_32x32x16_bf16 v[48:63], v[84:87], v[80:83], v[48:63]
    s_add_u32 m0, s30, 17408
    s_add_u32 s73, s95, 1498112
    s_sub_u32 s0, s73, 1605632
    s_min_u32 s73, s73, s0
    buffer_load_dwordx4 v44, s[52:55], s73 offen lds
    v_mfma_f32_32x32x16_bf16 v[48:63], v[92:95], v[88:91], v[48:63]
    s_waitcnt vmcnt(10) lgkmcnt(0)
    s_barrier
    s_add_u32 m0, s29, 49152
    s_add_u32 s73, s94, 106496
    s_sub_u32 s0, s73, 114688
    s_min_u32 s73, s73, s0
    s_add_u32 s73, s73, s93
    buffer_load_dwordx4 v6, s[48:51], s73 offen offset:0 sc1 lds
    buffer_load_dwordx4 v6, s[48:51], s73 offen offset:1024 sc1 lds
    v_mfma_f32_32x32x16_bf16 v[48:63], v[100:103], v[96:99], v[48:63]
    ds_read_b128 v[64:67], v2 offset:16384
    ds_read_b64_tr_b16 v[68:69], v5 offset:0
    ds_read_b64_tr_b16 v[70:71], v5 offset:512
    ds_read_b128 v[72:75], v2 offset:17408
    ds_read_b64_tr_b16 v[76:77], v5 offset:2048
    ds_read_b64_tr_b16 v[78:79], v5 offset:2560
    ds_read_b128 v[80:83], v2 offset:18432
    ds_read_b64_tr_b16 v[84:85], v5 offset:4096
    ds_read_b64_tr_b16 v[86:87], v5 offset:4608
    ds_read_b128 v[88:91], v2 offset:19456
    ds_read_b64_tr_b16 v[92:93], v5 offset:6144
    ds_read_b64_tr_b16 v[94:95], v5 offset:6656
    v_mfma_f32_32x32x16_bf16 v[48:63], v[108:111], v[104:107], v[48:63]
    s_add_u32 m0, s30, 32768
    s_add_u32 s73, s89, 0
    s_and_b32 s73, s73, 3
    s_mul_i32 s73, s73, 100352
    s_add_u32 s73, s73, s28
    buffer_load_dwordx4 v44, s[56:59], s73 offen lds
    v_mfma_f32_32x32x16_bf16 v[48:63], v[116:119], v[112:115], v[48:63]
    s_add_u32 m0, s30, 33792
    s_add_u32 s73, s89, 0
    s_and_b32 s73, s73, 3
    s_mul_i32 s73, s73, 100352
    s_add_u32 s73, s73, s28
    s_add_u32 s73, s73, 7168
    buffer_load_dwordx4 v44, s[56:59], s73 offen lds
    v_mfma_f32_32x32x16_bf16 v[48:63], v[124:127], v[120:123], v[48:63]
    s_cmp_lg_u32 s68, 0
    s_nop 10
    s_cbranch_scc1 L_wf_done7
    s_mov_b32 s76, 0
    s_waitcnt vmcnt(12)
L_wf7:
    v_cmp_eq_u64 vcc, v[254:255], v[248:249]
    s_nop 0
    s_and_b32 s75, vcc_lo, 65535
    s_cmp_eq_u32 s75, 65535
    s_nop 1
    s_cbranch_scc1 L_wf_done7
    s_add_u32 s76, s76, 1
    s_cmp_gt_u32 s76, 100000
    s_cbranch_scc1 L_wf_done7
    s_sleep 4
    buffer_load_dwordx2 v[254:255], v46, s[48:51], 0 offen sc1
    s_waitcnt vmcnt(0)
    s_branch L_wf7
L_wf_done7:
    s_waitcnt vmcnt(10) lgkmcnt(0)
    s_barrier
    s_add_u32 m0, s29, 16384
    s_add_u32 s73, s89, 0
    s_and_b32 s73, s73, 3
    s_lshl_b32 s73, s73, 13
    s_add_u32 s73, s73, 114688
    s_add_u32 s73, s73, s93
    buffer_load_dwordx4 v6, s[48:51], s73 offen offset:0 sc1 lds
    buffer_load_dwordx4 v6, s[48:51], s73 offen offset:1024 sc1 lds
    v_mfma_f32_32x32x16_bf16 v[48:63], v[68:71], v[64:67], v[48:63]
    ds_read_b128 v[96:99], v2 offset:32768
    ds_read_b64_tr_b16 v[100:101], v5 offset:16384
    ds_read_b64_tr_b16 v[102:103], v5 offset:16896
    ds_read_b128 v[104:107], v2 offset:33792
    ds_read_b64_tr_b16 v[108:109], v5 offset:18432
    ds_read_b64_tr_b16 v[110:111], v5 offset:18944
    ds_read_b128 v[112:115], v2 offset:34816
    ds_read_b64_tr_b16 v[116:117], v5 offset:20480
    ds_read_b64_tr_b16 v[118:119], v5 offset:20992
    ds_read_b128 v[120:123], v2 offset:35840
    ds_read_b64_tr_b16 v[124:125], v5 offset:22528
    ds_read_b64_tr_b16 v[126:127], v5 offset:23040
    v_mfma_f32_32x32x16_bf16 v[48:63], v[76:79], v[72:75], v[48:63]
    s_add_u32 m0, s30, 49152
    s_add_u32 s73, s89, 1
    s_and_b32 s73, s73, 3
    s_mul_i32 s73, s73, 100352
    s_add_u32 s73, s73, s28
    buffer_load_dwordx4 v44, s[56:59], s73 offen lds
    v_mfma_f32_32x32x16_bf16 v[48:63], v[84:87], v[80:83], v[48:63]
    v_mfma_f32_32x32x16_bf16 v[48:63], v[92:95], v[88:91], v[48:63]
    s_waitcnt vmcnt(9) lgkmcnt(0)
    s_barrier
    s_add_u32 m0, s29, 32768
    s_add_u32 s73, s89, 1
    s_and_b32 s73, s73, 3
    s_lshl_b32 s73, s73, 13
    s_add_u32 s73, s73, 114688
    s_add_u32 s73, s73, s93
    buffer_load_dwordx4 v6, s[48:51], s73 offen offset:0 sc1 lds
    buffer_load_dwordx4 v6, s[48:51], s73 offen offset:1024 sc1 lds
    v_mfma_f32_32x32x16_bf16 v[48:63], v[100:103], v[96:99], v[48:63]
    ds_read_b128 v[64:67], v2 offset:0
    ds_read_b64_tr_b16 v[68:69], v3 offset:0
    ds_read_b64_tr_b16 v[70:71], v3 offset:512
    ds_read_b128 v[72:75], v2 offset:1024
    ds_read_b64_tr_b16 v[76:77], v3 offset:2048
    ds_read_b64_tr_b16 v[78:79], v3 offset:2560
    ds_read_b128 v[80:83], v2 offset:2048
    ds_read_b64_tr_b16 v[84:85], v3 offset:4096
    ds_read_b64_tr_b16 v[86:87], v3 offset:4608
    ds_read_b128 v[88:91], v2 offset:3072
    ds_read_b64_tr_b16 v[92:93], v3 offset:6144
    ds_read_b64_tr_b16 v[94:95], v3 offset:6656
    v_mfma_f32_32x32x16_bf16 v[48:63], v[108:111], v[104:107], v[48:63]
    s_add_u32 m0, s30, 50176
    s_add_u32 s73, s89, 1
    s_and_b32 s73, s73, 3
    s_mul_i32 s73, s73, 100352
    s_add_u32 s73, s73, s28
    s_add_u32 s73, s73, 7168
    buffer_load_dwordx4 v44, s[56:59], s73 offen lds
    v_mfma_f32_32x32x16_bf16 v[48:63], v[116:119], v[112:115], v[48:63]
    s_add_u32 m0, s30, 65536
    s_add_u32 s73, s89, 2
    s_and_b32 s73, s73, 3
    s_mul_i32 s73, s73, 100352
    s_add_u32 s73, s73, s28
    buffer_load_dwordx4 v44, s[56:59], s73 offen lds
    v_mfma_f32_32x32x16_bf16 v[48:63], v[124:127], v[120:123], v[48:63]
    s_waitcnt vmcnt(9) lgkmcnt(0)
    s_barrier
    s_add_u32 m0, s29, 0
    s_add_u32 s73, s89, 2
    s_and_b32 s73, s73, 3
    s_lshl_b32 s73, s73, 13
    s_add_u32 s73, s73, 114688
    s_add_u32 s73, s73, s93
    buffer_load_dwordx4 v6, s[48:51], s73 offen offset:0 sc1 lds
    buffer_load_dwordx4 v6, s[48:51], s73 offen offset:1024 sc1 lds
    v_mfma_f32_32x32x16_bf16 v[48:63], v[68:71], v[64:67], v[48:63]
    ds_read_b128 v[96:99], v2 offset:49152
    ds_read_b64_tr_b16 v[100:101], v3 offset:16384
    ds_read_b64_tr_b16 v[102:103], v3 offset:16896
    ds_read_b128 v[104:107], v2 offset:50176
    ds_read_b64_tr_b16 v[108:109], v3 offset:18432
    ds_read_b64_tr_b16 v[110:111], v3 offset:18944
    ds_read_b128 v[112:115], v2 offset:51200
    ds_read_b64_tr_b16 v[116:117], v3 offset:20480
    ds_read_b64_tr_b16 v[118:119], v3 offset:20992
    ds_read_b128 v[120:123], v2 offset:52224
    ds_read_b64_tr_b16 v[124:125], v3 offset:22528
    ds_read_b64_tr_b16 v[126:127], v3 offset:23040
    v_mfma_f32_32x32x16_bf16 v[48:63], v[76:79], v[72:75], v[48:63]
    s_add_u32 m0, s30, 66560
    s_add_u32 s73, s89, 2
    s_and_b32 s73, s73, 3
    s_mul_i32 s73, s73, 100352
    s_add_u32 s73, s73, s28
    s_add_u32 s73, s73, 7168
    buffer_load_dwordx4 v44, s[56:59], s73 offen lds
    v_mfma_f32_32x32x16_bf16 v[48:63], v[84:87], v[80:83], v[48:63]
    s_add_u32 m0, s30, 81920
    s_add_u32 s73, s89, 3
    s_and_b32 s73, s73, 3
    s_mul_i32 s73, s73, 100352
    s_add_u32 s73, s73, s28
    buffer_load_dwordx4 v44, s[56:59], s73 offen lds
    v_mfma_f32_32x32x16_bf16 v[48:63], v[92:95], v[88:91], v[48:63]
    s_waitcnt vmcnt(9) lgkmcnt(0)
    s_barrier
    s_add_u32 m0, s29, 49152
    s_add_u32 s73, s89, 3
    s_and_b32 s73, s73, 3
    s_lshl_b32 s73, s73, 13
    s_add_u32 s73, s73, 114688
    s_add_u32 s73, s73, s93
    buffer_load_dwordx4 v6, s[48:51], s73 offen offset:0 sc1 lds
    buffer_load_dwordx4 v6, s[48:51], s73 offen offset:1024 sc1 lds
    v_mfma_f32_32x32x16_bf16 v[48:63], v[100:103], v[96:99], v[48:63]
    ds_read_b128 v[64:67], v2 offset:16384
    ds_read_b64_tr_b16 v[68:69], v3 offset:32768
    ds_read_b64_tr_b16 v[70:71], v3 offset:33280
    ds_read_b128 v[72:75], v2 offset:17408
    ds_read_b64_tr_b16 v[76:77], v3 offset:34816
    ds_read_b64_tr_b16 v[78:79], v3 offset:35328
    ds_read_b128 v[80:83], v2 offset:18432
    ds_read_b64_tr_b16 v[84:85], v3 offset:36864
    ds_read_b64_tr_b16 v[86:87], v3 offset:37376
    ds_read_b128 v[88:91], v2 offset:19456
    ds_read_b64_tr_b16 v[92:93], v3 offset:38912
    ds_read_b64_tr_b16 v[94:95], v3 offset:39424
    v_mfma_f32_32x32x16_bf16 v[48:63], v[108:111], v[104:107], v[48:63]
    s_add_u32 m0, s30, 82944
    s_add_u32 s73, s89, 3
    s_and_b32 s73, s73, 3
    s_mul_i32 s73, s73, 100352
    s_add_u32 s73, s73, s28
    s_add_u32 s73, s73, 7168
    buffer_load_dwordx4 v44, s[56:59], s73 offen lds
    v_mfma_f32_32x32x16_bf16 v[48:63], v[116:119], v[112:115], v[48:63]
    v_mfma_f32_32x32x16_bf16 v[48:63], v[124:127], v[120:123], v[48:63]
    s_waitcnt vmcnt(8) lgkmcnt(0)
    s_barrier
    v_mfma_f32_32x32x16_bf16 v[48:63], v[68:71], v[64:67], v[48:63]
    ds_read_b128 v[96:99], v2 offset:32768
    ds_read_b64_tr_b16 v[100:101], v3 offset:49152
    ds_read_b64_tr_b16 v[102:103], v3 offset:49664
    ds_read_b128 v[104:107], v2 offset:33792
    ds_read_b64_tr_b16 v[108:109], v3 offset:51200
    ds_read_b64_tr_b16 v[110:111], v3 offset:51712
    ds_read_b128 v[112:115], v2 offset:34816
    ds_read_b64_tr_b16 v[116:117], v3 offset:53248
    ds_read_b64_tr_b16 v[118:119], v3 offset:53760
    ds_read_b128 v[120:123], v2 offset:35840
    ds_read_b64_tr_b16 v[124:125], v3 offset:55296
    ds_read_b64_tr_b16 v[126:127], v3 offset:55808
    v_mfma_f32_32x32x16_bf16 v[48:63], v[76:79], v[72:75], v[48:63]
    v_mfma_f32_32x32x16_bf16 v[48:63], v[84:87], v[80:83], v[48:63]
    v_mfma_f32_32x32x16_bf16 v[48:63], v[92:95], v[88:91], v[48:63]
    s_waitcnt vmcnt(4) lgkmcnt(0)
    s_barrier
    v_mfma_f32_32x32x16_bf16 v[48:63], v[100:103], v[96:99], v[48:63]
    ds_read_b128 v[64:67], v2 offset:0
    ds_read_b64_tr_b16 v[68:69], v5 offset:0
    ds_read_b64_tr_b16 v[70:71], v5 offset:512
    ds_read_b128 v[72:75], v2 offset:1024
    ds_read_b64_tr_b16 v[76:77], v5 offset:2048
    ds_read_b64_tr_b16 v[78:79], v5 offset:2560
    ds_read_b128 v[80:83], v2 offset:2048
    ds_read_b64_tr_b16 v[84:85], v5 offset:4096
    ds_read_b64_tr_b16 v[86:87], v5 offset:4608
    ds_read_b128 v[88:91], v2 offset:3072
    ds_read_b64_tr_b16 v[92:93], v5 offset:6144
    ds_read_b64_tr_b16 v[94:95], v5 offset:6656
    v_mfma_f32_32x32x16_bf16 v[48:63], v[108:111], v[104:107], v[48:63]
    v_mfma_f32_32x32x16_bf16 v[48:63], v[116:119], v[112:115], v[48:63]
    v_mfma_f32_32x32x16_bf16 v[48:63], v[124:127], v[120:123], v[48:63]
    s_waitcnt vmcnt(0) lgkmcnt(0)
    s_barrier
    v_mfma_f32_32x32x16_bf16 v[48:63], v[68:71], v[64:67], v[48:63]
    ds_read_b128 v[96:99], v2 offset:49152
    ds_read_b64_tr_b16 v[100:101], v5 offset:16384
    ds_read_b64_tr_b16 v[102:103], v5 offset:16896
    ds_read_b128 v[104:107], v2 offset:50176
    ds_read_b64_tr_b16 v[108:109], v5 offset:18432
    ds_read_b64_tr_b16 v[110:111], v5 offset:18944
    ds_read_b128 v[112:115], v2 offset:51200
    ds_read_b64_tr_b16 v[116:117], v5 offset:20480
    ds_read_b64_tr_b16 v[118:119], v5 offset:20992
    ds_read_b128 v[120:123], v2 offset:52224
    ds_read_b64_tr_b16 v[124:125], v5 offset:22528
    ds_read_b64_tr_b16 v[126:127], v5 offset:23040
    v_mfma_f32_32x32x16_bf16 v[48:63], v[76:79], v[72:75], v[48:63]
    v_mfma_f32_32x32x16_bf16 v[48:63], v[84:87], v[80:83], v[48:63]
    v_mfma_f32_32x32x16_bf16 v[48:63], v[92:95], v[88:91], v[48:63]
    s_waitcnt lgkmcnt(0)
    v_mfma_f32_32x32x16_bf16 v[48:63], v[100:103], v[96:99], v[48:63]
    v_mfma_f32_32x32x16_bf16 v[48:63], v[108:111], v[104:107], v[48:63]
    v_mfma_f32_32x32x16_bf16 v[48:63], v[116:119], v[112:115], v[48:63]
    v_mfma_f32_32x32x16_bf16 v[48:63], v[124:127], v[120:123], v[48:63]
    s_lshl_b32 s74, s68, 11
    s_add_u32 s74, s74, 98304
    v_add_u32 v21, s74, v6
    v_xor_b32 v22, 8192, v21
    s_cmp_eq_u32 s90, 0
    s_nop 6
    s_cbranch_scc1 L_k0
    ds_write_b128 v21, v[48:51]
    ds_write_b128 v21, v[52:55] offset:1024
    v_mov_b32 v48, v56
    v_mov_b32 v49, v57
    v_mov_b32 v50, v58
    v_mov_b32 v51, v59
    v_mov_b32 v52, v60
    v_mov_b32 v53, v61
    v_mov_b32 v54, v62
    v_mov_b32 v55, v63
    s_nop 1
    s_branch L_k1
L_k0:
    ds_write_b128 v21, v[56:59]
    ds_write_b128 v21, v[60:63] offset:1024
L_k1:
    s_waitcnt vmcnt(0) lgkmcnt(0)
    s_barrier
    ds_read_b128 v[64:67], v22
    ds_read_b128 v[68:71], v22 offset:1024
    v_lshlrev_b32 v72, 16, v40
    v_and_b32 v73, 0xffff0000, v40
    v_lshlrev_b32 v74, 16, v41
    v_and_b32 v75, 0xffff0000, v41
    v_lshlrev_b32 v76, 16, v42
    v_and_b32 v77, 0xffff0000, v42
    v_lshlrev_b32 v78, 16, v43
    v_and_b32 v79, 0xffff0000, v43
    v_add_f32 v48, v48, v72
    v_add_f32 v49, v49, v73
    v_add_f32 v50, v50, v74
    v_add_f32 v51, v51, v75
    v_add_f32 v52, v52, v76
    v_add_f32 v53, v53, v77
    v_add_f32 v54, v54, v78
    v_add_f32 v55, v55, v79
    s_waitcnt lgkmcnt(0)
    v_add_f32 v48, v48, v64
    v_add_f32 v49, v49, v65
    v_add_f32 v50, v50, v66
    v_add_f32 v51, v51, v67
    v_add_f32 v52, v52, v68
    v_add_f32 v53, v53, v69
    v_add_f32 v54, v54, v70
    v_add_f32 v55, v55, v71
    v_cvt_pk_bf16_f32 v40, v48, v49
    v_cvt_pk_bf16_f32 v41, v50, v51
    v_cvt_pk_bf16_f32 v42, v52, v53
    v_cvt_pk_bf16_f32 v43, v54, v55
    buffer_store_dwordx4 v[40:43], v9, s[60:63], s31 offen
    s_nop 1
L_end:
    s_endpgm
.section .rodata,"a"
.p2align 6
.amdhsa_kernel parallel_sum__sliding_block__geglu_ffn__prompt_kernel
  .amdhsa_next_free_vgpr 256
  .amdhsa_next_free_sgpr 102
  .amdhsa_accum_offset 256
  .amdhsa_group_segment_fixed_size 0
  .amdhsa_kernarg_size 80
  .amdhsa_user_sgpr_count 2
  .amdhsa_user_sgpr_kernarg_segment_ptr 1
  .amdhsa_system_sgpr_workgroup_id_x 1
.end_amdhsa_kernel
```
